```python
import torch

def _softmax(x, axis=-1):
    return torch.softmax(x, dim=axis)
def _gelu(x):
    return torch.nn.functional.gelu(x, approximate="tanh")
def _silu(x):
    return torch.nn.functional.silu(x)
def _sigmoid(x):
    return torch.sigmoid(x)
def _layernorm(x, axis=-1, eps=1e-5):
    m = x.mean(dim=axis, keepdim=True)
    v = x.var(dim=axis, keepdim=True, unbiased=False)
    return (x - m) / torch.sqrt(v + eps)
def _scatter_add(tgt, idx, src, axis=0):
    return tgt.clone().index_add_(axis, idx, src)
def _segment_sum(src, seg, n):
    out = torch.zeros((n,) + src.shape[1:], dtype=src.dtype)
    return out.index_add_(0, seg, src)
def _pad(x, pw):
    flat = tuple(v for pair in reversed(pw) for v in pair)
    return torch.nn.functional.pad(x, flat)

kernel_name = 'parallel_sum__sliding_local_dilated__mixer_channel_mlp__prompt'

def setup_inputs():

    _w = (lambda a: (lambda t: t.to(torch.bfloat16) if t.is_floating_point() else t)(torch.as_tensor(a)))
    def _A_setup():
        B, S, D = 1, 2048, 512
        return {
            "x": _w((lambda *s: torch.randn(*s, dtype=torch.bfloat16) * 0.05)(B, S, D)),
            "wqkv": _w((lambda *s: torch.randn(*s, dtype=torch.bfloat16) * 0.05)(D, 3 * D)),
            "wo": _w((lambda *s: torch.randn(*s, dtype=torch.bfloat16) * 0.05)(D, D)),
        }
    _A_in = _A_setup()

    def _B_setup():
        B, S, D, F = 1, 2048, 512, 1376
        return {
            "x": _w((lambda *s: torch.randn(*s, dtype=torch.bfloat16) * 0.05)(B, S, D)),
            "w1": _w((lambda *s: torch.randn(*s, dtype=torch.bfloat16) * 3.2)(D, F) * (D ** -0.5)),
            "b1": _w((lambda *s: torch.randn(*s, dtype=torch.bfloat16) * 1.6)(F)),
            "w2": _w((lambda *s: torch.randn(*s, dtype=torch.bfloat16) * 0.2)(F, D) * (F ** -0.5)),
            "b2": _w((lambda *s: torch.randn(*s, dtype=torch.bfloat16) * 0.2)(D)),
        }
    _B_in = _B_setup()

    return {
        "A_x": _A_in["x"],
        "A_wqkv": _A_in["wqkv"],
        "A_wo": _A_in["wo"],
        "B_x": _B_in["x"],
        "B_w1": _B_in["w1"],
        "B_b1": _B_in["b1"],
        "B_w2": _B_in["w2"],
        "B_b2": _B_in["b2"],
    }

def reference(A_x, A_wqkv, A_wo, B_x, B_w1, B_b1, B_w2, B_b2):
    def _A_ref(x, wqkv, wo):
        B, S, D = x.shape
        H = 32; Dh = D // H
        W, dil = 8, 2
        qkv = (lambda x, *d: x.permute(*d))((x @ wqkv).reshape(B, S, 3, H, Dh), 2, 0, 3, 1, 4)
        q, k, v = qkv[0], qkv[1], qkv[2]
        scale = Dh ** -0.5
        pos = torch.arange(S)
        off = torch.arange(W) * dil
        idx = pos[:, None] - off[None, :]
        mask = idx >= 0
        idx_c = torch.where(mask, idx, 0).reshape(-1)
        kg = k[:, :, idx_c, :].reshape(B, H, S, W, Dh)
        vg = v[:, :, idx_c, :].reshape(B, H, S, W, Dh)
        logits = torch.einsum("bhsd,bhswd->bhsw", q, kg) * scale
        logits = torch.where(mask[None, None, :, :], logits, -1e9)
        attn = _softmax(logits, axis=-1)
        o = torch.einsum("bhsw,bhswd->bhsd", attn, vg)
        return (lambda x, *d: x.permute(*d))(o, 0, 2, 1, 3).reshape(B, S, D) @ wo

    def _B_ref(x, w1, b1, w2, b2):
        y = _layernorm(x, axis=-1)
        h = _gelu(torch.einsum("bsd,df->bsf", y, w1) + b1)
        return torch.einsum("bsf,fd->bsd", h, w2) + b2

    x = A_x
    xn = _layernorm(x, axis=-1)
    return x + _A_ref(xn, A_wqkv, A_wo) + _B_ref(xn, B_w1, B_b1, B_w2, B_b2)
```

```asm
; @launch grid=(256,1,1) block=(512,1,1) lds=163840
.amdgcn_target "amdgcn-amd-amdhsa--gfx950"
.text
.globl parallel_sum__sliding_local_dilated__mixer_channel_mlp__prompt_kernel
.p2align 8
.type parallel_sum__sliding_local_dilated__mixer_channel_mlp__prompt_kernel,@function
parallel_sum__sliding_local_dilated__mixer_channel_mlp__prompt_kernel:
s_cmp_ge_u32 s2, 256
s_cbranch_scc1 L_end
s_load_dwordx16 s[4:19], s[0:1], 0
s_load_dwordx4 s[20:23], s[0:1], 64
s_load_dwordx2 s[24:25], s[0:1], 80
s_getpc_b64 s[98:99]
L_pc:
v_lshrrev_b32 v1, 6, v0
v_and_b32 v0, 63, v0
v_readfirstlane_b32 s26, v1
s_and_b32 s52, s2, 7
s_lshr_b32 s53, s2, 3
s_lshr_b32 s27, s52, 1
s_lshl_b32 s27, s27, 2
s_lshr_b32 s54, s53, 3
s_add_u32 s27, s27, s54
s_bfe_u32 s62, s53, 0x10002
s_and_b32 s63, s52, 1
s_lshl_b32 s63, s63, 2
s_and_b32 s55, s53, 3
s_add_u32 s63, s63, s55
s_lshl_b32 s28, s62, 3
s_add_u32 s28, s28, s63
s_lshl_b32 s32, s52, 2
s_add_u32 s32, s32, s54
s_and_b32 s33, s53, 7
s_mul_i32 s29, s63, 6
s_mul_i32 s54, s63, 5
s_add_u32 s54, s54, 3
s_cmp_lt_u32 s63, 3
s_cselect_b32 s29, s29, s54
s_cselect_b32 s30, 6, 5
s_lshl_b32 s31, s27, 7
s_mov_b32 s35, 0xffff0000
s_and_b32 s34, s26, 3
v_mov_b32 v6, 0
v_mov_b32 v7, 0
s_cmp_lt_u32 s26, 4
s_cbranch_scc1 L_compute
L_helper:
v_lshrrev_b32 v1, 3, v0
v_and_b32 v2, 7, v0
v_lshrrev_b32 v6, 4, v0
v_xor_b32 v10, v2, v6
v_lshlrev_b32 v10, 4, v10
s_lshl_b32 s52, s34, 5
s_add_u32 s52, s52, s31
v_add_u32 v3, s52, v1
v_lshl_add_u32 v3, v3, 10, v10
v_xor_b32 v4, 64, v3
v_add_u32 v4, 8192, v4
s_lshl_b32 s52, s34, 3
s_add_u32 s52, s52, s31
s_sub_u32 s52, s52, 16
v_add_u32 v5, s52, v1
v_lshl_add_u32 v5, v5, 10, v10
s_and_b32 s52, s34, 1
s_lshl_b32 s52, s52, 6
v_xor_b32 v5, s52, v5
s_lshr_b32 s52, s34, 1
s_or_b32 s52, s52, s62
s_cmp_eq_u32 s52, 0
s_cselect_b32 s96, 1, 0
s_lshl_b32 s95, s34, 10
s_cmp_eq_u32 s52, 0
s_cselect_b32 s95, s95, 134144
s_cselect_b32 s53, 0, 0x80000000
s_cmp_eq_u32 s27, 0
s_cselect_b32 s53, 0x80000000, s53
v_or_b32 v5, s53, v5
s_cmp_eq_u32 s62, 0
s_mov_b32 s53, 2752
s_cselect_b32 s52, 3072, s53
s_mov_b32 s54, 128
s_cselect_b32 s92, 1024, s54
s_lshl_b32 s59, s52, 6
v_and_b32 v6, 1, v6
v_lshlrev_b32 v6, 1, v6
v_xor_b32 v6, v6, v2
v_lshlrev_b32 v6, 4, v6
s_lshl_b32 s53, s34, 4
v_add_u32 v8, s53, v1
v_mul_u32_u24 v8, s52, v8
s_lshl_b32 s54, s52, 3
v_add_u32 v9, s54, v8
v_add_u32 v8, v8, v6
v_xor_b32 v6, 64, v6
v_add_u32 v9, v9, v6
s_lshl_b32 s53, s63, 7
s_lshl_b32 s54, s29, 6
s_cmp_eq_u32 s62, 0
s_cselect_b32 s58, s53, s54
s_lshl_b32 s93, s34, 12
s_add_u32 s93, s93, 2048
s_lshl_b32 s94, s34, 11
s_add_u32 s94, s94, 18432
v_lshlrev_b32 v7, 4, v0
s_mov_b32 s56, 0
s_mov_b32 s57, 0
s_and_b32 s52, s27, 3
s_lshl_b32 s100, s52, 1
s_mov_b32 s101, s58
s_lshl_b32 s57, s100, 7
s_mul_i32 s52, s100, s59
s_add_u32 s58, s101, s52
s_waitcnt lgkmcnt(0)
s_mov_b32 s36, s4
s_and_b32 s37, s5, 0xffff
s_mov_b32 s38, 2097152
s_mov_b32 s39, 0x20000
s_cmp_eq_u32 s62, 0
s_cselect_b32 s40, s6, s12
s_cselect_b32 s41, s7, s13
s_mov_b32 s52, 1409024
s_cselect_b32 s42, 1572864, s52
s_and_b32 s41, s41, 0xffff
s_mov_b32 s43, 0x20000
s_mov_b32 s44, s24
s_and_b32 s45, s25, 0xffff
s_mov_b32 s46, 8519680
s_mov_b32 s47, 0x20000
v_mov_b32 v36, 0
v_mov_b32 v37, 0
s_mov_b32 s60, 1
s_mov_b32 s97, 0
v_mov_b32 v38, 151808
v_mov_b32 v39, 0
v_mov_b32 v40, 0
v_mov_b32 v41, 0
v_mov_b32 v42, 0
v_mov_b32 v43, 0
ds_write_b128 v38, v[40:43]
s_or_b32 s52, s2, s34
s_cmp_lg_u32 s52, 0
s_cbranch_scc1 L_nonon
s_memrealtime s[60:61]
s_waitcnt lgkmcnt(0)
s_or_b32 s60, s60, 1
v_mov_b32 v36, s60
v_mov_b32 v37, 0
s_mov_b64 exec, 1
global_store_dword v37, v36, s[22:23] sc1
s_mov_b64 exec, -1
L_nonon:
s_add_u32 m0, s56, s94
s_add_u32 s53, s58, s92
buffer_load_dwordx4 v8, s[40:43], s58 offen lds
s_add_u32 m0, m0, 8192
s_add_u32 s54, s53, s92
buffer_load_dwordx4 v8, s[40:43], s53 offen lds
s_add_u32 m0, m0, 8192
s_nop 0
buffer_load_dwordx4 v8, s[40:43], s54 offen lds
s_add_u32 m0, s56, s93
s_add_u32 s55, s57, 16384
buffer_load_dwordx4 v3, s[36:39], s57 offen lds
s_add_u32 m0, m0, 1024
s_nop 0
buffer_load_dwordx4 v4, s[36:39], s57 offen lds
s_add_u32 m0, s56, s94
s_add_u32 m0, m0, 1024
s_nop 0
buffer_load_dwordx4 v9, s[40:43], s58 offen lds
s_add_u32 m0, m0, 8192
s_nop 0
buffer_load_dwordx4 v9, s[40:43], s53 offen lds
s_add_u32 m0, m0, 8192
s_nop 0
buffer_load_dwordx4 v9, s[40:43], s54 offen lds
s_add_u32 m0, s56, s93
s_add_u32 m0, m0, 2048
s_nop 0
buffer_load_dwordx4 v3, s[36:39], s55 offen lds
s_add_u32 m0, m0, 1024
s_nop 0
buffer_load_dwordx4 v4, s[36:39], s55 offen lds
s_mul_i32 s52, s56, s96
s_add_u32 m0, s52, s95
s_nop 0
buffer_load_dwordx4 v5, s[36:39], s57 offen lds
s_add_u32 s57, s57, 128
s_add_u32 s58, s58, s59
s_cmp_eq_u32 s57, 1024
s_cselect_b32 s57, 0, s57
s_cselect_b32 s58, s101, s58
s_add_u32 s56, s56, 43008
s_cmp_eq_u32 s56, 129024
s_cselect_b32 s56, 0, s56
s_add_u32 m0, s56, s94
s_add_u32 s53, s58, s92
buffer_load_dwordx4 v8, s[40:43], s58 offen lds
s_add_u32 m0, m0, 8192
s_add_u32 s54, s53, s92
buffer_load_dwordx4 v8, s[40:43], s53 offen lds
s_add_u32 m0, m0, 8192
s_nop 0
buffer_load_dwordx4 v8, s[40:43], s54 offen lds
s_add_u32 m0, s56, s93
s_add_u32 s55, s57, 16384
buffer_load_dwordx4 v3, s[36:39], s57 offen lds
s_add_u32 m0, m0, 1024
s_nop 0
buffer_load_dwordx4 v4, s[36:39], s57 offen lds
s_add_u32 m0, s56, s94
s_add_u32 m0, m0, 1024
s_nop 0
buffer_load_dwordx4 v9, s[40:43], s58 offen lds
s_add_u32 m0, m0, 8192
s_nop 0
buffer_load_dwordx4 v9, s[40:43], s53 offen lds
s_add_u32 m0, m0, 8192
s_nop 0
buffer_load_dwordx4 v9, s[40:43], s54 offen lds
s_add_u32 m0, s56, s93
s_add_u32 m0, m0, 2048
s_nop 0
buffer_load_dwordx4 v3, s[36:39], s55 offen lds
s_add_u32 m0, m0, 1024
s_nop 0
buffer_load_dwordx4 v4, s[36:39], s55 offen lds
s_mul_i32 s52, s56, s96
s_add_u32 m0, s52, s95
s_nop 0
buffer_load_dwordx4 v5, s[36:39], s57 offen lds
s_add_u32 s57, s57, 128
s_add_u32 s58, s58, s59
s_cmp_eq_u32 s57, 1024
s_cselect_b32 s57, 0, s57
s_cselect_b32 s58, s101, s58
s_add_u32 s56, s56, 43008
s_cmp_eq_u32 s56, 129024
s_cselect_b32 s56, 0, s56
s_waitcnt vmcnt(11) lgkmcnt(0)
s_barrier
s_add_u32 m0, s56, s94
s_add_u32 s53, s58, s92
buffer_load_dwordx4 v8, s[40:43], s58 offen lds
s_add_u32 m0, m0, 8192
s_add_u32 s54, s53, s92
buffer_load_dwordx4 v8, s[40:43], s53 offen lds
s_add_u32 m0, m0, 8192
s_nop 0
buffer_load_dwordx4 v8, s[40:43], s54 offen lds
s_add_u32 m0, s56, s93
s_add_u32 s55, s57, 16384
buffer_load_dwordx4 v3, s[36:39], s57 offen lds
s_add_u32 m0, m0, 1024
s_nop 0
buffer_load_dwordx4 v4, s[36:39], s57 offen lds
s_add_u32 m0, s56, s94
s_add_u32 m0, m0, 1024
s_nop 0
buffer_load_dwordx4 v9, s[40:43], s58 offen lds
s_add_u32 m0, m0, 8192
s_nop 0
buffer_load_dwordx4 v9, s[40:43], s53 offen lds
s_add_u32 m0, m0, 8192
s_nop 0
buffer_load_dwordx4 v9, s[40:43], s54 offen lds
s_add_u32 m0, s56, s93
s_add_u32 m0, m0, 2048
s_nop 0
buffer_load_dwordx4 v3, s[36:39], s55 offen lds
s_add_u32 m0, m0, 1024
s_nop 0
buffer_load_dwordx4 v4, s[36:39], s55 offen lds
s_mul_i32 s52, s56, s96
s_add_u32 m0, s52, s95
s_nop 0
buffer_load_dwordx4 v5, s[36:39], s57 offen lds
s_add_u32 s57, s57, 128
s_add_u32 s58, s58, s59
s_cmp_eq_u32 s57, 1024
s_cselect_b32 s57, 0, s57
s_cselect_b32 s58, s101, s58
s_add_u32 s56, s56, 43008
s_cmp_eq_u32 s56, 129024
s_cselect_b32 s56, 0, s56
s_cmp_lg_u32 s34, 0
s_cbranch_scc1 L_nost
v_add_u32 v36, 151616, v7
ds_read_b128 v[40:43], v36
s_lshl_b32 s52, s28, 3
s_add_u32 s52, s52, s31
s_lshl_b32 s52, s52, 4
s_add_u32 s52, s52, 8388608
s_waitcnt lgkmcnt(0)
s_mov_b64 exec, 0xff
buffer_store_dwordx4 v[40:43], v7, s[44:47], s52 offen sc1
s_mov_b64 exec, -1
v_mov_b32 v37, 0
global_load_dword v38, v37, s[22:23]
L_nost:
s_waitcnt vmcnt(11)
s_barrier
s_add_u32 m0, s56, s94
s_add_u32 s53, s58, s92
buffer_load_dwordx4 v8, s[40:43], s58 offen lds
s_add_u32 m0, m0, 8192
s_add_u32 s54, s53, s92
buffer_load_dwordx4 v8, s[40:43], s53 offen lds
s_add_u32 m0, m0, 8192
s_nop 0
buffer_load_dwordx4 v8, s[40:43], s54 offen lds
s_add_u32 m0, s56, s93
s_add_u32 s55, s57, 16384
buffer_load_dwordx4 v3, s[36:39], s57 offen lds
s_add_u32 m0, m0, 1024
s_nop 0
buffer_load_dwordx4 v4, s[36:39], s57 offen lds
s_add_u32 m0, s56, s94
s_add_u32 m0, m0, 1024
s_nop 0
buffer_load_dwordx4 v9, s[40:43], s58 offen lds
s_add_u32 m0, m0, 8192
s_nop 0
buffer_load_dwordx4 v9, s[40:43], s53 offen lds
s_add_u32 m0, m0, 8192
s_nop 0
buffer_load_dwordx4 v9, s[40:43], s54 offen lds
s_add_u32 m0, s56, s93
s_add_u32 m0, m0, 2048
s_nop 0
buffer_load_dwordx4 v3, s[36:39], s55 offen lds
s_add_u32 m0, m0, 1024
s_nop 0
buffer_load_dwordx4 v4, s[36:39], s55 offen lds
s_mul_i32 s52, s56, s96
s_add_u32 m0, s52, s95
s_nop 0
buffer_load_dwordx4 v5, s[36:39], s57 offen lds
s_add_u32 s57, s57, 128
s_add_u32 s58, s58, s59
s_cmp_eq_u32 s57, 1024
s_cselect_b32 s57, 0, s57
s_cselect_b32 s58, s101, s58
s_add_u32 s56, s56, 43008
s_cmp_eq_u32 s56, 129024
s_cselect_b32 s56, 0, s56
s_waitcnt vmcnt(11)
s_barrier
s_cmp_lg_u32 s34, 0
s_cbranch_scc1 L_h0b
v_readfirstlane_b32 s97, v38
s_nop 1
s_cmp_lg_u32 s97, 0
s_cbranch_scc1 L_non_ok
s_mov_b32 s52, 65536
v_mov_b32 v37, 0
L_non_poll:
global_load_dword v38, v37, s[22:23] sc1
s_waitcnt vmcnt(0)
v_readfirstlane_b32 s97, v38
s_nop 1
s_cmp_lg_u32 s97, 0
s_cbranch_scc1 L_non_ok
s_sleep 2
s_sub_u32 s52, s52, 1
s_cmp_lg_u32 s52, 0
s_cbranch_scc1 L_non_poll
L_non_ok:
v_mov_b32 v39, s97
s_waitcnt vmcnt(0)
s_lshl_b32 s52, s27, 4
s_add_u32 s52, s52, s28
s_lshl_b32 s52, s52, 7
s_add_u32 s52, s52, 8454144
v_mov_b32 v36, s52
s_mov_b64 exec, 1
buffer_store_dword v39, v36, s[44:47], 0 offen sc1
s_mov_b64 exec, -1
v_mov_b32 v36, 151552
ds_write_b32 v36, v39
L_h0b:
s_add_u32 m0, s56, s94
s_add_u32 s53, s58, s92
buffer_load_dwordx4 v8, s[40:43], s58 offen lds
s_add_u32 m0, m0, 8192
s_add_u32 s54, s53, s92
buffer_load_dwordx4 v8, s[40:43], s53 offen lds
s_add_u32 m0, m0, 8192
s_nop 0
buffer_load_dwordx4 v8, s[40:43], s54 offen lds
s_add_u32 m0, s56, s93
s_add_u32 s55, s57, 16384
buffer_load_dwordx4 v3, s[36:39], s57 offen lds
s_add_u32 m0, m0, 1024
s_nop 0
buffer_load_dwordx4 v4, s[36:39], s57 offen lds
s_add_u32 m0, s56, s94
s_add_u32 m0, m0, 1024
s_nop 0
buffer_load_dwordx4 v9, s[40:43], s58 offen lds
s_add_u32 m0, m0, 8192
s_nop 0
buffer_load_dwordx4 v9, s[40:43], s53 offen lds
s_add_u32 m0, m0, 8192
s_nop 0
buffer_load_dwordx4 v9, s[40:43], s54 offen lds
s_add_u32 m0, s56, s93
s_add_u32 m0, m0, 2048
s_nop 0
buffer_load_dwordx4 v3, s[36:39], s55 offen lds
s_add_u32 m0, m0, 1024
s_nop 0
buffer_load_dwordx4 v4, s[36:39], s55 offen lds
s_mul_i32 s52, s56, s96
s_add_u32 m0, s52, s95
s_nop 0
buffer_load_dwordx4 v5, s[36:39], s57 offen lds
s_add_u32 s57, s57, 128
s_add_u32 s58, s58, s59
s_cmp_eq_u32 s57, 1024
s_cselect_b32 s57, 0, s57
s_cselect_b32 s58, s101, s58
s_add_u32 s56, s56, 43008
s_cmp_eq_u32 s56, 129024
s_cselect_b32 s56, 0, s56
s_waitcnt vmcnt(11)
s_barrier
s_add_u32 m0, s56, s94
s_add_u32 s53, s58, s92
buffer_load_dwordx4 v8, s[40:43], s58 offen lds
s_add_u32 m0, m0, 8192
s_add_u32 s54, s53, s92
buffer_load_dwordx4 v8, s[40:43], s53 offen lds
s_add_u32 m0, m0, 8192
s_nop 0
buffer_load_dwordx4 v8, s[40:43], s54 offen lds
s_add_u32 m0, s56, s93
s_add_u32 s55, s57, 16384
buffer_load_dwordx4 v3, s[36:39], s57 offen lds
s_add_u32 m0, m0, 1024
s_nop 0
buffer_load_dwordx4 v4, s[36:39], s57 offen lds
s_add_u32 m0, s56, s94
s_add_u32 m0, m0, 1024
s_nop 0
buffer_load_dwordx4 v9, s[40:43], s58 offen lds
s_add_u32 m0, m0, 8192
s_nop 0
buffer_load_dwordx4 v9, s[40:43], s53 offen lds
s_add_u32 m0, m0, 8192
s_nop 0
buffer_load_dwordx4 v9, s[40:43], s54 offen lds
s_add_u32 m0, s56, s93
s_add_u32 m0, m0, 2048
s_nop 0
buffer_load_dwordx4 v3, s[36:39], s55 offen lds
s_add_u32 m0, m0, 1024
s_nop 0
buffer_load_dwordx4 v4, s[36:39], s55 offen lds
s_mul_i32 s52, s56, s96
s_add_u32 m0, s52, s95
s_nop 0
buffer_load_dwordx4 v5, s[36:39], s57 offen lds
s_add_u32 s57, s57, 128
s_add_u32 s58, s58, s59
s_cmp_eq_u32 s57, 1024
s_cselect_b32 s57, 0, s57
s_cselect_b32 s58, s101, s58
s_add_u32 s56, s56, 43008
s_cmp_eq_u32 s56, 129024
s_cselect_b32 s56, 0, s56
s_waitcnt vmcnt(11)
s_barrier
s_cmp_lg_u32 s34, 0
s_cbranch_scc1 L_h0c
v_subrev_u32 v36, 18, v0
v_cmp_gt_u32 vcc, 16, v0
s_nop 1
v_cndmask_b32 v36, v36, v0, vcc
s_lshl_b32 s52, s27, 4
v_add_u32 v36, s52, v36
v_lshlrev_b32 v36, 7, v36
v_add_u32 v36, 8454144, v36
s_cmp_eq_u32 s27, 0
s_mov_b32 s60, 0x3ffff
s_cselect_b32 s60, 0xffff, s60
s_mov_b32 exec_lo, s60
s_mov_b32 exec_hi, 0
buffer_load_dword v38, v36, s[44:47], 0 offen sc1
s_mov_b64 exec, -1
L_h0c:
s_add_u32 m0, s56, s94
s_add_u32 s53, s58, s92
buffer_load_dwordx4 v8, s[40:43], s58 offen lds
s_add_u32 m0, m0, 8192
s_add_u32 s54, s53, s92
buffer_load_dwordx4 v8, s[40:43], s53 offen lds
s_add_u32 m0, m0, 8192
s_nop 0
buffer_load_dwordx4 v8, s[40:43], s54 offen lds
s_add_u32 m0, s56, s93
s_add_u32 s55, s57, 16384
buffer_load_dwordx4 v3, s[36:39], s57 offen lds
s_add_u32 m0, m0, 1024
s_nop 0
buffer_load_dwordx4 v4, s[36:39], s57 offen lds
s_add_u32 m0, s56, s94
s_add_u32 m0, m0, 1024
s_nop 0
buffer_load_dwordx4 v9, s[40:43], s58 offen lds
s_add_u32 m0, m0, 8192
s_nop 0
buffer_load_dwordx4 v9, s[40:43], s53 offen lds
s_add_u32 m0, m0, 8192
s_nop 0
buffer_load_dwordx4 v9, s[40:43], s54 offen lds
s_add_u32 m0, s56, s93
s_add_u32 m0, m0, 2048
s_nop 0
buffer_load_dwordx4 v3, s[36:39], s55 offen lds
s_add_u32 m0, m0, 1024
s_nop 0
buffer_load_dwordx4 v4, s[36:39], s55 offen lds
s_mul_i32 s52, s56, s96
s_add_u32 m0, s52, s95
s_nop 0
buffer_load_dwordx4 v5, s[36:39], s57 offen lds
s_add_u32 s57, s57, 128
s_add_u32 s58, s58, s59
s_cmp_eq_u32 s57, 1024
s_cselect_b32 s57, 0, s57
s_cselect_b32 s58, s101, s58
s_add_u32 s56, s56, 43008
s_cmp_eq_u32 s56, 129024
s_cselect_b32 s56, 0, s56
s_waitcnt vmcnt(11)
s_barrier
s_cmp_lg_u32 s34, 0
s_cbranch_scc1 L_h0d
s_mov_b32 exec_lo, s60
s_mov_b32 exec_hi, 0
v_cmp_eq_u32 vcc, s97, v38
s_mov_b64 exec, -1
s_nop 0
s_cmp_eq_u32 vcc_lo, s60
s_cbranch_scc1 L_p0ok
s_mov_b32 exec_lo, s60
s_mov_b32 exec_hi, 0
s_mov_b32 s52, 65536
L_poll_p0:
buffer_load_dword v38, v36, s[44:47], 0 offen sc1
s_waitcnt vmcnt(0)
v_cmp_eq_u32 vcc, s97, v38
s_nop 1
s_cmp_eq_u32 vcc_lo, s60
s_cbranch_scc1 L_polld_p0
s_sleep 2
s_sub_u32 s52, s52, 1
s_cmp_lg_u32 s52, 0
s_cbranch_scc1 L_poll_p0
L_polld_p0:
s_mov_b64 exec, -1
L_p0ok:
s_sub_u32 s52, s31, 16
s_lshl_b32 s52, s52, 4
s_add_u32 s52, s52, 8388608
v_add_u32 v36, s52, v7
s_cmp_eq_u32 s27, 0
s_cselect_b32 s53, 16, 0
v_cmp_gt_u32 vcc, s53, v0
v_mov_b32 v37, 0x80000000
s_nop 0
v_cndmask_b32 v37, v36, v37, vcc
buffer_load_dwordx4 v[40:43], v37, s[44:47], 0 offen sc1
buffer_load_dwordx4 v[44:47], v36, s[44:47], 0 offen offset:1024 sc1
s_mov_b64 exec, 0xffff
buffer_load_dwordx4 v[48:51], v36, s[44:47], 0 offen offset:2048 sc1
s_mov_b64 exec, -1
L_h0d:
s_add_u32 m0, s56, s94
s_add_u32 s53, s58, s92
buffer_load_dwordx4 v8, s[40:43], s58 offen lds
s_add_u32 m0, m0, 8192
s_add_u32 s54, s53, s92
buffer_load_dwordx4 v8, s[40:43], s53 offen lds
s_add_u32 m0, m0, 8192
s_nop 0
buffer_load_dwordx4 v8, s[40:43], s54 offen lds
s_add_u32 m0, s56, s93
s_add_u32 s55, s57, 16384
buffer_load_dwordx4 v3, s[36:39], s57 offen lds
s_add_u32 m0, m0, 1024
s_nop 0
buffer_load_dwordx4 v4, s[36:39], s57 offen lds
s_add_u32 m0, s56, s94
s_add_u32 m0, m0, 1024
s_nop 0
buffer_load_dwordx4 v9, s[40:43], s58 offen lds
s_add_u32 m0, m0, 8192
s_nop 0
buffer_load_dwordx4 v9, s[40:43], s53 offen lds
s_add_u32 m0, m0, 8192
s_nop 0
buffer_load_dwordx4 v9, s[40:43], s54 offen lds
s_add_u32 m0, s56, s93
s_add_u32 m0, m0, 2048
s_nop 0
buffer_load_dwordx4 v3, s[36:39], s55 offen lds
s_add_u32 m0, m0, 1024
s_nop 0
buffer_load_dwordx4 v4, s[36:39], s55 offen lds
s_mul_i32 s52, s56, s96
s_add_u32 m0, s52, s95
s_nop 0
buffer_load_dwordx4 v5, s[36:39], s57 offen lds
s_add_u32 s57, s57, 128
s_add_u32 s58, s58, s59
s_cmp_eq_u32 s57, 1024
s_cselect_b32 s57, 0, s57
s_cselect_b32 s58, s101, s58
s_add_u32 s56, s56, 43008
s_cmp_eq_u32 s56, 129024
s_cselect_b32 s56, 0, s56
s_cmp_eq_u32 s34, 0
s_cselect_b32 s48, s8, s16
s_cselect_b32 s49, s9, s17
s_mov_b32 s53, 1409024
s_cselect_b32 s50, 524288, s53
s_mov_b32 s51, 0x20000
s_and_b32 s49, s49, 0xffff
s_lshr_b32 s53, s2, 3
s_lshl_b32 s54, s53, 14
s_mul_i32 s53, s53, 44032
s_sub_u32 s55, s34, 1
s_lshl_b32 s55, s55, 14
s_add_u32 s53, s53, s55
s_cmp_eq_u32 s34, 0
s_cselect_b32 s53, s54, s53
v_lshlrev_b32 v12, 7, v0
buffer_load_dword v13, v12, s[48:51], s53 offen
s_add_u32 s53, s53, 8192
buffer_load_dword v14, v12, s[48:51], s53 offen
s_waitcnt vmcnt(13)
s_barrier
s_cmp_lg_u32 s34, 0
s_cbranch_scc1 L_h0e
v_lshlrev_b32 v36, 2, v0
v_add_u32 v36, 131072, v36
ds_write_b32 v36, v40 offset:0
ds_write_b32 v36, v41 offset:576
ds_write_b32 v36, v42 offset:1152
ds_write_b32 v36, v43 offset:1728
ds_write_b32 v36, v44 offset:256
ds_write_b32 v36, v45 offset:832
ds_write_b32 v36, v46 offset:1408
ds_write_b32 v36, v47 offset:1984
s_mov_b64 exec, 0xffff
ds_write_b32 v36, v48 offset:512
ds_write_b32 v36, v49 offset:1088
ds_write_b32 v36, v50 offset:1664
ds_write_b32 v36, v51 offset:2240
s_mov_b64 exec, -1
L_h0e:
s_waitcnt vmcnt(2) lgkmcnt(0)
s_barrier
s_barrier
s_cmp_eq_u32 s62, 0
s_cbranch_scc1 L_e1a
s_barrier
L_e1a:
v_lshrrev_b32 v6, 4, v0
v_lshlrev_b32 v6, 1, v6
v_and_b32 v8, 7, v0
v_xor_b32 v6, v6, v8
v_lshlrev_b32 v6, 4, v6
v_lshrrev_b32 v8, 3, v0
v_lshl_add_u32 v6, v8, 10, v6
s_lshl_b32 s52, s33, 7
v_add_u32 v10, s52, v6
v_lshlrev_b32 v11, 4, v0
s_mov_b32 s36, s8
s_and_b32 s37, s9, 0xffff
s_mov_b32 s38, 524288
s_mov_b32 s39, 0x20000
s_mov_b32 s40, s16
s_and_b32 s41, s17, 0xffff
s_mov_b32 s42, 1409024
s_mov_b32 s43, 0x20000
s_lshl_b32 s56, s34, 12
s_lshl_b32 s57, s34, 15
s_add_u32 s58, s57, 131072
s_mul_i32 s60, s34, 6
s_mul_i32 s53, s34, 5
s_add_u32 s53, s53, 3
s_cmp_lt_u32 s34, 3
s_cselect_b32 s60, s60, s53
s_lshl_b32 s60, s60, 15
s_mul_i32 s59, s26, 6
s_mul_i32 s53, s26, 5
s_add_u32 s53, s53, 3
s_cmp_lt_u32 s26, 3
s_cselect_b32 s59, s59, s53
s_lshl_b32 s59, s59, 15
s_add_u32 s61, s60, 163840
s_cmp_lt_u32 s34, 3
s_cselect_b32 s61, s61, 0x80000000
s_add_u32 m0, s56, 0
s_add_u32 s53, s58, 0
buffer_load_dwordx4 v10, s[36:39], s53 offen lds
s_add_u32 m0, s56, 1024
s_add_u32 s53, s58, 8192
buffer_load_dwordx4 v10, s[36:39], s53 offen lds
s_add_u32 m0, s56, 2048
s_add_u32 s53, s58, 16384
buffer_load_dwordx4 v10, s[36:39], s53 offen lds
s_add_u32 m0, s56, 3072
s_add_u32 s53, s58, 24576
buffer_load_dwordx4 v10, s[36:39], s53 offen lds
v_and_b32 v8, 15, v0
v_lshrrev_b32 v9, 4, v0
v_mov_b32 v12, v10
v_lshrrev_b32 v6, 2, v8
v_lshl_add_u32 v6, v9, 2, v6
v_lshrrev_b32 v7, 1, v6
v_and_b32 v7, 3, v7
v_lshlrev_b32 v7, 5, v7
v_lshlrev_b32 v6, 7, v6
v_and_b32 v10, 3, v8
v_lshl_add_u32 v6, v10, 3, v6
v_add_u32 v6, s56, v6
v_xor_b32 v1, 0, v7
v_add_u32 v2, v6, v1
v_xor_b32 v1, 32, v7
v_add_u32 v3, v6, v1
v_xor_b32 v1, 64, v7
v_add_u32 v4, v6, v1
v_xor_b32 v1, 96, v7
v_add_u32 v5, v6, v1
s_waitcnt vmcnt(0)
ds_read_b64_tr_b16 v[124:125], v2 offset:0
ds_read_b64_tr_b16 v[126:127], v2 offset:2048
ds_read_b64_tr_b16 v[128:129], v3 offset:0
ds_read_b64_tr_b16 v[130:131], v3 offset:2048
ds_read_b64_tr_b16 v[132:133], v4 offset:0
ds_read_b64_tr_b16 v[134:135], v4 offset:2048
ds_read_b64_tr_b16 v[136:137], v5 offset:0
ds_read_b64_tr_b16 v[138:139], v5 offset:2048
s_add_u32 m0, s56, 16384
s_add_u32 s53, s58, 262144
buffer_load_dwordx4 v12, s[36:39], s53 offen lds
s_add_u32 m0, s56, 17408
s_add_u32 s53, s58, 270336
buffer_load_dwordx4 v12, s[36:39], s53 offen lds
s_add_u32 m0, s56, 18432
s_add_u32 s53, s58, 278528
buffer_load_dwordx4 v12, s[36:39], s53 offen lds
s_add_u32 m0, s56, 19456
s_add_u32 s53, s58, 286720
buffer_load_dwordx4 v12, s[36:39], s53 offen lds
s_waitcnt lgkmcnt(0)
s_add_u32 m0, s56, 0
s_add_u32 s53, s57, 0
buffer_load_dwordx4 v12, s[36:39], s53 offen lds
s_add_u32 m0, s56, 1024
s_add_u32 s53, s57, 8192
buffer_load_dwordx4 v12, s[36:39], s53 offen lds
s_add_u32 m0, s56, 2048
s_add_u32 s53, s57, 16384
buffer_load_dwordx4 v12, s[36:39], s53 offen lds
s_add_u32 m0, s56, 3072
s_add_u32 s53, s57, 24576
buffer_load_dwordx4 v12, s[36:39], s53 offen lds
s_waitcnt vmcnt(4)
ds_read_b64_tr_b16 v[140:141], v2 offset:16384
ds_read_b64_tr_b16 v[142:143], v2 offset:18432
ds_read_b64_tr_b16 v[144:145], v3 offset:16384
ds_read_b64_tr_b16 v[146:147], v3 offset:18432
ds_read_b64_tr_b16 v[148:149], v4 offset:16384
ds_read_b64_tr_b16 v[150:151], v4 offset:18432
ds_read_b64_tr_b16 v[152:153], v5 offset:16384
ds_read_b64_tr_b16 v[154:155], v5 offset:18432
s_add_u32 m0, s56, 32768
s_add_u32 s53, s59, 0
buffer_load_dwordx4 v12, s[40:43], s53 offen lds
s_add_u32 m0, s56, 33792
s_add_u32 s53, s59, 8192
buffer_load_dwordx4 v12, s[40:43], s53 offen lds
s_add_u32 m0, s56, 34816
s_add_u32 s53, s59, 16384
buffer_load_dwordx4 v12, s[40:43], s53 offen lds
s_add_u32 m0, s56, 35840
s_add_u32 s53, s59, 24576
buffer_load_dwordx4 v12, s[40:43], s53 offen lds
s_waitcnt lgkmcnt(0)
s_add_u32 m0, s56, 16384
s_add_u32 s53, s57, 262144
buffer_load_dwordx4 v12, s[36:39], s53 offen lds
s_add_u32 m0, s56, 17408
s_add_u32 s53, s57, 270336
buffer_load_dwordx4 v12, s[36:39], s53 offen lds
s_add_u32 m0, s56, 18432
s_add_u32 s53, s57, 278528
buffer_load_dwordx4 v12, s[36:39], s53 offen lds
s_add_u32 m0, s56, 19456
s_add_u32 s53, s57, 286720
buffer_load_dwordx4 v12, s[36:39], s53 offen lds
s_waitcnt vmcnt(4)
ds_read_b64_tr_b16 v[156:157], v2 offset:32768
ds_read_b64_tr_b16 v[158:159], v2 offset:34816
ds_read_b64_tr_b16 v[160:161], v3 offset:32768
ds_read_b64_tr_b16 v[162:163], v3 offset:34816
ds_read_b64_tr_b16 v[164:165], v4 offset:32768
ds_read_b64_tr_b16 v[166:167], v4 offset:34816
ds_read_b64_tr_b16 v[168:169], v5 offset:32768
ds_read_b64_tr_b16 v[170:171], v5 offset:34816
s_add_u32 m0, s56, 49152
s_add_u32 s53, s59, 98304
buffer_load_dwordx4 v12, s[40:43], s53 offen lds
s_add_u32 m0, s56, 50176
s_add_u32 s53, s59, 106496
buffer_load_dwordx4 v12, s[40:43], s53 offen lds
s_add_u32 m0, s56, 51200
s_add_u32 s53, s59, 114688
buffer_load_dwordx4 v12, s[40:43], s53 offen lds
s_add_u32 m0, s56, 52224
s_add_u32 s53, s59, 122880
buffer_load_dwordx4 v12, s[40:43], s53 offen lds
s_waitcnt lgkmcnt(0)
s_add_u32 m0, s56, 32768
s_add_u32 s53, s60, 0
buffer_load_dwordx4 v12, s[40:43], s53 offen lds
s_add_u32 m0, s56, 33792
s_add_u32 s53, s60, 8192
buffer_load_dwordx4 v12, s[40:43], s53 offen lds
s_add_u32 m0, s56, 34816
s_add_u32 s53, s60, 16384
buffer_load_dwordx4 v12, s[40:43], s53 offen lds
s_add_u32 m0, s56, 35840
s_add_u32 s53, s60, 24576
buffer_load_dwordx4 v12, s[40:43], s53 offen lds
s_waitcnt vmcnt(4)
ds_read_b64_tr_b16 v[172:173], v2 offset:49152
ds_read_b64_tr_b16 v[174:175], v2 offset:51200
ds_read_b64_tr_b16 v[176:177], v3 offset:49152
ds_read_b64_tr_b16 v[178:179], v3 offset:51200
ds_read_b64_tr_b16 v[180:181], v4 offset:49152
ds_read_b64_tr_b16 v[182:183], v4 offset:51200
ds_read_b64_tr_b16 v[184:185], v5 offset:49152
ds_read_b64_tr_b16 v[186:187], v5 offset:51200
s_add_u32 m0, s56, 65536
s_add_u32 s53, s59, 32768
buffer_load_dwordx4 v12, s[40:43], s53 offen lds
s_add_u32 m0, s56, 66560
s_add_u32 s53, s59, 40960
buffer_load_dwordx4 v12, s[40:43], s53 offen lds
s_add_u32 m0, s56, 67584
s_add_u32 s53, s59, 49152
buffer_load_dwordx4 v12, s[40:43], s53 offen lds
s_add_u32 m0, s56, 68608
s_add_u32 s53, s59, 57344
buffer_load_dwordx4 v12, s[40:43], s53 offen lds
s_waitcnt lgkmcnt(0)
s_add_u32 m0, s56, 49152
s_add_u32 s53, s60, 98304
buffer_load_dwordx4 v12, s[40:43], s53 offen lds
s_add_u32 m0, s56, 50176
s_add_u32 s53, s60, 106496
buffer_load_dwordx4 v12, s[40:43], s53 offen lds
s_add_u32 m0, s56, 51200
s_add_u32 s53, s60, 114688
buffer_load_dwordx4 v12, s[40:43], s53 offen lds
s_add_u32 m0, s56, 52224
s_add_u32 s53, s60, 122880
buffer_load_dwordx4 v12, s[40:43], s53 offen lds
v_add_u32 v2, 65536, v2
v_add_u32 v3, 65536, v3
v_add_u32 v4, 65536, v4
v_add_u32 v5, 65536, v5
s_waitcnt vmcnt(4)
ds_read_b64_tr_b16 v[188:189], v2 offset:0
ds_read_b64_tr_b16 v[190:191], v2 offset:2048
ds_read_b64_tr_b16 v[192:193], v3 offset:0
ds_read_b64_tr_b16 v[194:195], v3 offset:2048
ds_read_b64_tr_b16 v[196:197], v4 offset:0
ds_read_b64_tr_b16 v[198:199], v4 offset:2048
ds_read_b64_tr_b16 v[200:201], v5 offset:0
ds_read_b64_tr_b16 v[202:203], v5 offset:2048
s_add_u32 m0, s56, 81920
s_add_u32 s53, s59, 131072
buffer_load_dwordx4 v12, s[40:43], s53 offen lds
s_add_u32 m0, s56, 82944
s_add_u32 s53, s59, 139264
buffer_load_dwordx4 v12, s[40:43], s53 offen lds
s_add_u32 m0, s56, 83968
s_add_u32 s53, s59, 147456
buffer_load_dwordx4 v12, s[40:43], s53 offen lds
s_add_u32 m0, s56, 84992
s_add_u32 s53, s59, 155648
buffer_load_dwordx4 v12, s[40:43], s53 offen lds
s_waitcnt lgkmcnt(0)
s_add_u32 m0, s56, 65536
s_add_u32 s53, s60, 32768
buffer_load_dwordx4 v12, s[40:43], s53 offen lds
s_add_u32 m0, s56, 66560
s_add_u32 s53, s60, 40960
buffer_load_dwordx4 v12, s[40:43], s53 offen lds
s_add_u32 m0, s56, 67584
s_add_u32 s53, s60, 49152
buffer_load_dwordx4 v12, s[40:43], s53 offen lds
s_add_u32 m0, s56, 68608
s_add_u32 s53, s60, 57344
buffer_load_dwordx4 v12, s[40:43], s53 offen lds
s_waitcnt vmcnt(4)
ds_read_b64_tr_b16 v[204:205], v2 offset:16384
ds_read_b64_tr_b16 v[206:207], v2 offset:18432
ds_read_b64_tr_b16 v[208:209], v3 offset:16384
ds_read_b64_tr_b16 v[210:211], v3 offset:18432
ds_read_b64_tr_b16 v[212:213], v4 offset:16384
ds_read_b64_tr_b16 v[214:215], v4 offset:18432
ds_read_b64_tr_b16 v[216:217], v5 offset:16384
ds_read_b64_tr_b16 v[218:219], v5 offset:18432
s_add_u32 m0, s56, 98304
s_add_u32 s53, s59, 65536
buffer_load_dwordx4 v12, s[40:43], s53 offen lds
s_add_u32 m0, s56, 99328
s_add_u32 s53, s59, 73728
buffer_load_dwordx4 v12, s[40:43], s53 offen lds
s_add_u32 m0, s56, 100352
s_add_u32 s53, s59, 81920
buffer_load_dwordx4 v12, s[40:43], s53 offen lds
s_add_u32 m0, s56, 101376
s_add_u32 s53, s59, 90112
buffer_load_dwordx4 v12, s[40:43], s53 offen lds
s_waitcnt lgkmcnt(0)
s_add_u32 m0, s56, 81920
s_add_u32 s53, s60, 131072
buffer_load_dwordx4 v12, s[40:43], s53 offen lds
s_add_u32 m0, s56, 82944
s_add_u32 s53, s60, 139264
buffer_load_dwordx4 v12, s[40:43], s53 offen lds
s_add_u32 m0, s56, 83968
s_add_u32 s53, s60, 147456
buffer_load_dwordx4 v12, s[40:43], s53 offen lds
s_add_u32 m0, s56, 84992
s_add_u32 s53, s60, 155648
buffer_load_dwordx4 v12, s[40:43], s53 offen lds
s_waitcnt vmcnt(4)
ds_read_b64_tr_b16 v[220:221], v2 offset:32768
ds_read_b64_tr_b16 v[222:223], v2 offset:34816
ds_read_b64_tr_b16 v[224:225], v3 offset:32768
ds_read_b64_tr_b16 v[226:227], v3 offset:34816
ds_read_b64_tr_b16 v[228:229], v4 offset:32768
ds_read_b64_tr_b16 v[230:231], v4 offset:34816
ds_read_b64_tr_b16 v[232:233], v5 offset:32768
ds_read_b64_tr_b16 v[234:235], v5 offset:34816
s_waitcnt lgkmcnt(0)
s_add_u32 m0, s56, 98304
s_add_u32 s53, s60, 65536
buffer_load_dwordx4 v12, s[40:43], s53 offen lds
s_add_u32 m0, s56, 99328
s_add_u32 s53, s60, 73728
buffer_load_dwordx4 v12, s[40:43], s53 offen lds
s_add_u32 m0, s56, 100352
s_add_u32 s53, s60, 81920
buffer_load_dwordx4 v12, s[40:43], s53 offen lds
s_add_u32 m0, s56, 101376
s_add_u32 s53, s60, 90112
buffer_load_dwordx4 v12, s[40:43], s53 offen lds
s_add_u32 m0, s56, 114688
s_add_u32 s53, s61, 0
buffer_load_dwordx4 v12, s[40:43], s53 offen lds
s_add_u32 m0, s56, 115712
s_add_u32 s53, s61, 8192
buffer_load_dwordx4 v12, s[40:43], s53 offen lds
s_add_u32 m0, s56, 116736
s_add_u32 s53, s61, 16384
buffer_load_dwordx4 v12, s[40:43], s53 offen lds
s_add_u32 m0, s56, 117760
s_add_u32 s53, s61, 24576
buffer_load_dwordx4 v12, s[40:43], s53 offen lds
v_mov_b32 v236, 0
v_mov_b32 v237, 0
v_mov_b32 v238, 0
v_mov_b32 v239, 0
v_mov_b32 v240, 0
v_mov_b32 v241, 0
v_mov_b32 v242, 0
v_mov_b32 v243, 0
v_mov_b32 v244, 0
v_mov_b32 v245, 0
v_mov_b32 v246, 0
v_mov_b32 v247, 0
v_mov_b32 v248, 0
v_mov_b32 v249, 0
v_mov_b32 v250, 0
v_mov_b32 v251, 0
s_mov_b32 s44, s24
s_and_b32 s45, s25, 0xffff
s_mov_b32 s46, 8519680
s_mov_b32 s47, 0x20000
s_lshr_b32 s52, s32, 1
s_lshl_b32 s52, s52, 4
v_add_u32 v6, s52, v0
v_lshlrev_b32 v6, 7, v6
v_add_u32 v6, 8454148, v6
s_cmp_lg_u32 s34, 0
s_cbranch_scc1 L_nef
s_mov_b64 exec, 0xffff
buffer_load_dword v7, v6, s[44:47], 0 offen sc1
s_mov_b64 exec, -1
s_waitcnt vmcnt(0)
s_mov_b64 exec, 0xffff
v_cmp_eq_u32 vcc, s97, v7
s_mov_b64 exec, -1
s_nop 0
s_mov_b32 s60, vcc_lo
v_mov_b32 v10, 151820
v_mov_b32 v11, s60
ds_write_b32 v10, v11
s_waitcnt lgkmcnt(0)
L_nef:
s_waitcnt vmcnt(0)
s_branch L_p2
L_compute:
v_lshlrev_b32 v7, 4, v0
s_lshl_b32 s52, s28, 3
s_add_u32 s52, s52, s31
s_lshl_b32 s53, s26, 1
s_add_u32 s52, s52, s53
s_lshl_b32 s60, s52, 10
s_lshl_b32 s61, s52, 4
s_waitcnt lgkmcnt(0)
s_mov_b32 s48, s4
s_and_b32 s49, s5, 0xffff
s_mov_b32 s50, 2097152
s_mov_b32 s51, 0x20000
buffer_load_dwordx4 v[16:19], v7, s[48:51], s60 offen
buffer_load_dwordx4 v[20:23], v7, s[48:51], s60 offen offset:1024
s_lshr_b32 s53, s2, 3
s_lshl_b32 s54, s26, 5
s_add_u32 s53, s53, s54
s_lshl_b32 s53, s53, 10
v_add_u32 v2, s53, v7
s_mov_b32 s54, L_code_end-L_pc-16
v_min_u32 v2, s54, v2
global_load_dwordx4 v[248:251], v2, s[98:99]
v_mov_b32 v2, s8
v_mov_b32 v3, s9
s_add_u32 s52, s8, 0
s_addc_u32 s53, s9, 0
v_writelane_b32 v2, s52, 0
v_writelane_b32 v3, s53, 0
s_add_u32 s52, s16, 0
s_addc_u32 s53, s17, 0
v_writelane_b32 v2, s52, 1
v_writelane_b32 v3, s53, 1
s_add_u32 s52, s16, 1048576
s_addc_u32 s53, s17, 0
v_writelane_b32 v2, s52, 2
v_writelane_b32 v3, s53, 2
s_add_u32 s52, s14, 0
s_addc_u32 s53, s15, 0
v_writelane_b32 v2, s52, 3
v_writelane_b32 v3, s53, 3
s_add_u32 s52, s18, 0
s_addc_u32 s53, s19, 0
v_writelane_b32 v2, s52, 4
v_writelane_b32 v3, s53, 4
s_add_u32 s52, s20, 0
s_addc_u32 s53, s21, 0
v_writelane_b32 v2, s52, 5
v_writelane_b32 v3, s53, 5
s_add_u32 s52, s20, 1048576
s_addc_u32 s53, s21, 0
v_writelane_b32 v2, s52, 6
v_writelane_b32 v3, s53, 6
s_add_u32 s52, s24, 60416
s_addc_u32 s53, s25, 0
v_writelane_b32 v2, s52, 7
v_writelane_b32 v3, s53, 7
s_add_u32 s52, s24, 2149376
s_addc_u32 s53, s25, 0
v_writelane_b32 v2, s52, 8
v_writelane_b32 v3, s53, 8
s_add_u32 s52, s24, 4238336
s_addc_u32 s53, s25, 0
v_writelane_b32 v2, s52, 9
v_writelane_b32 v3, s53, 9
s_add_u32 s52, s24, 6327296
s_addc_u32 s53, s25, 0
v_writelane_b32 v2, s52, 10
v_writelane_b32 v3, s53, 10
s_add_u32 s52, s24, 8421376
s_addc_u32 s53, s25, 0
v_writelane_b32 v2, s52, 11
v_writelane_b32 v3, s53, 11
s_add_u32 s52, s22, 128
s_addc_u32 s53, s23, 0
v_writelane_b32 v2, s52, 12
v_writelane_b32 v3, s53, 12
s_mov_b64 exec, 8191
global_load_dword v252, v[2:3], off
s_mov_b64 exec, -1
s_cmp_eq_u32 s62, 1
s_cbranch_scc1 L_typeM
L_typeA:
v_and_b32 v8, 15, v0
v_lshrrev_b32 v9, 4, v0
v_lshrrev_b32 v2, 1, v8
v_xor_b32 v2, v2, v9
v_lshlrev_b32 v2, 4, v2
v_lshl_add_u32 v10, v8, 7, v2
v_lshrrev_b32 v2, 2, v8
v_lshl_add_u32 v2, v9, 3, v2
v_lshlrev_b32 v2, 7, v2
v_and_b32 v3, 3, v8
v_lshl_add_u32 v2, v3, 3, v2
v_add_u32 v2, 18432, v2
v_bfe_u32 v3, v8, 3, 1
v_and_b32 v1, 1, v9
v_lshl_add_u32 v3, v1, 1, v3
v_lshlrev_b32 v3, 5, v3
v_mov_b32 v244, 0x3f803f80
v_mov_b32 v245, 0x3f803f80
v_mov_b32 v246, 0x3f803f80
v_mov_b32 v247, 0x3f803f80
v_xor_b32 v11, 64, v10
s_lshl_b32 s52, s26, 5
v_xor_b32 v3, s52, v3
v_add_u32 v13, v2, v3
v_mov_b32 v128, 0
v_mov_b32 v129, 0
v_mov_b32 v130, 0
v_mov_b32 v131, 0
v_mov_b32 v132, 0
v_mov_b32 v133, 0
v_mov_b32 v134, 0
v_mov_b32 v135, 0
v_mov_b32 v136, 0
v_mov_b32 v137, 0
v_mov_b32 v138, 0
v_mov_b32 v139, 0
v_mov_b32 v140, 0
v_mov_b32 v141, 0
v_mov_b32 v142, 0
v_mov_b32 v143, 0
v_mov_b32 v144, 0
v_mov_b32 v145, 0
v_mov_b32 v146, 0
v_mov_b32 v147, 0
v_mov_b32 v148, 0
v_mov_b32 v149, 0
v_mov_b32 v150, 0
v_mov_b32 v151, 0
v_mov_b32 v152, 0
v_mov_b32 v153, 0
v_mov_b32 v154, 0
v_mov_b32 v155, 0
v_mov_b32 v156, 0
v_mov_b32 v157, 0
v_mov_b32 v158, 0
v_mov_b32 v159, 0
v_mov_b32 v160, 0
v_mov_b32 v161, 0
v_mov_b32 v162, 0
v_mov_b32 v163, 0
v_mov_b32 v164, 0
v_mov_b32 v165, 0
v_mov_b32 v166, 0
v_mov_b32 v167, 0
v_mov_b32 v168, 0
v_mov_b32 v169, 0
v_mov_b32 v170, 0
v_mov_b32 v171, 0
v_mov_b32 v172, 0
v_mov_b32 v173, 0
v_mov_b32 v174, 0
v_mov_b32 v175, 0
v_mov_b32 v176, 0
v_mov_b32 v177, 0
v_mov_b32 v178, 0
v_mov_b32 v179, 0
v_mov_b32 v180, 0
v_mov_b32 v181, 0
v_mov_b32 v182, 0
v_mov_b32 v183, 0
v_mov_b32 v184, 0
v_mov_b32 v185, 0
v_mov_b32 v186, 0
v_mov_b32 v187, 0
v_mov_b32 v188, 0
v_mov_b32 v189, 0
v_mov_b32 v190, 0
v_mov_b32 v191, 0
v_mov_b32 v192, 0
v_mov_b32 v193, 0
v_mov_b32 v194, 0
v_mov_b32 v195, 0
v_mov_b32 v196, 0
v_mov_b32 v197, 0
v_mov_b32 v198, 0
v_mov_b32 v199, 0
v_mov_b32 v200, 0
v_mov_b32 v201, 0
v_mov_b32 v202, 0
v_mov_b32 v203, 0
v_mov_b32 v204, 0
v_mov_b32 v205, 0
v_mov_b32 v206, 0
v_mov_b32 v207, 0
v_mov_b32 v208, 0
v_mov_b32 v209, 0
v_mov_b32 v210, 0
v_mov_b32 v211, 0
v_mov_b32 v212, 0
v_mov_b32 v213, 0
v_mov_b32 v214, 0
v_mov_b32 v215, 0
v_mov_b32 v216, 0
v_mov_b32 v217, 0
v_mov_b32 v218, 0
v_mov_b32 v219, 0
v_mov_b32 v220, 0
v_mov_b32 v221, 0
v_mov_b32 v222, 0
v_mov_b32 v223, 0
v_mov_b32 v224, 0
v_mov_b32 v225, 0
v_mov_b32 v226, 0
v_mov_b32 v227, 0
v_mov_b32 v228, 0
v_mov_b32 v229, 0
v_mov_b32 v230, 0
v_mov_b32 v231, 0
v_mov_b32 v232, 0
v_mov_b32 v233, 0
v_mov_b32 v234, 0
v_mov_b32 v235, 0
v_mov_b32 v236, 0
v_mov_b32 v237, 0
v_mov_b32 v238, 0
v_mov_b32 v239, 0
v_mov_b32 v240, 0
v_mov_b32 v241, 0
v_mov_b32 v242, 0
v_mov_b32 v243, 0
s_mov_b32 s56, 0
s_mov_b32 s57, 0
s_mov_b32 s36, s24
s_and_b32 s37, s25, 0xffff
s_mov_b32 s38, 7864320
s_mov_b32 s39, 0x20000
s_waitcnt vmcnt(2)
v_mov_b32 v24, 0
v_mov_b32 v25, 0
v_mov_b32 v26, 0
v_mov_b32 v27, 0
v_mov_b32 v28, 0x3f803f80
v_dot2c_f32_bf16 v24, v16, v28
v_dot2c_f32_bf16 v25, v16, v16
v_dot2c_f32_bf16 v26, v20, v28
v_dot2c_f32_bf16 v27, v20, v20
v_dot2c_f32_bf16 v24, v17, v28
v_dot2c_f32_bf16 v25, v17, v17
v_dot2c_f32_bf16 v26, v21, v28
v_dot2c_f32_bf16 v27, v21, v21
v_dot2c_f32_bf16 v24, v18, v28
v_dot2c_f32_bf16 v25, v18, v18
v_dot2c_f32_bf16 v26, v22, v28
v_dot2c_f32_bf16 v27, v22, v22
v_dot2c_f32_bf16 v24, v19, v28
v_dot2c_f32_bf16 v25, v19, v19
v_dot2c_f32_bf16 v26, v23, v28
v_dot2c_f32_bf16 v27, v23, v23
s_nop 1
v_add_f32_dpp v24, v24, v24 row_ror:8 row_mask:0xf bank_mask:0xf
v_add_f32_dpp v25, v25, v25 row_ror:8 row_mask:0xf bank_mask:0xf
v_add_f32_dpp v26, v26, v26 row_ror:8 row_mask:0xf bank_mask:0xf
v_add_f32_dpp v27, v27, v27 row_ror:8 row_mask:0xf bank_mask:0xf
v_add_f32_dpp v24, v24, v24 row_ror:4 row_mask:0xf bank_mask:0xf
v_add_f32_dpp v25, v25, v25 row_ror:4 row_mask:0xf bank_mask:0xf
v_add_f32_dpp v26, v26, v26 row_ror:4 row_mask:0xf bank_mask:0xf
v_add_f32_dpp v27, v27, v27 row_ror:4 row_mask:0xf bank_mask:0xf
v_add_f32_dpp v24, v24, v24 row_ror:2 row_mask:0xf bank_mask:0xf
v_add_f32_dpp v25, v25, v25 row_ror:2 row_mask:0xf bank_mask:0xf
v_add_f32_dpp v26, v26, v26 row_ror:2 row_mask:0xf bank_mask:0xf
v_add_f32_dpp v27, v27, v27 row_ror:2 row_mask:0xf bank_mask:0xf
v_add_f32_dpp v24, v24, v24 row_ror:1 row_mask:0xf bank_mask:0xf
v_add_f32_dpp v25, v25, v25 row_ror:1 row_mask:0xf bank_mask:0xf
v_add_f32_dpp v26, v26, v26 row_ror:1 row_mask:0xf bank_mask:0xf
v_add_f32_dpp v27, v27, v27 row_ror:1 row_mask:0xf bank_mask:0xf
v_mov_b32 v28, v24
v_mov_b32 v29, v25
v_mov_b32 v30, v26
v_mov_b32 v31, v27
v_permlane16_swap_b32 v24, v28
v_permlane16_swap_b32 v25, v29
v_permlane16_swap_b32 v26, v30
v_permlane16_swap_b32 v27, v31
v_add_f32 v24, v24, v28
v_add_f32 v25, v25, v29
v_add_f32 v26, v26, v30
v_add_f32 v27, v27, v31
v_mov_b32 v28, v24
v_mov_b32 v29, v25
v_mov_b32 v30, v26
v_mov_b32 v31, v27
v_permlane32_swap_b32 v24, v28
v_permlane32_swap_b32 v25, v29
v_permlane32_swap_b32 v26, v30
v_permlane32_swap_b32 v27, v31
v_add_f32 v24, v24, v28
v_add_f32 v25, v25, v29
v_add_f32 v26, v26, v30
v_add_f32 v27, v27, v31
v_and_b32 v28, 1, v0
v_cmp_eq_u32 vcc, 1, v28
s_nop 1
v_cndmask_b32 v24, v24, v26, vcc
v_cndmask_b32 v25, v25, v27, vcc
v_mul_f32 v24, 0x3b000000, v24
v_mul_f32 v25, 0x3b000000, v25
v_fma_f32 v25, -v24, v24, v25
v_max_f32 v25, 0, v25
v_cvt_pk_bf16_f32 v33, v24, v24
v_and_b32 v33, s35, v33
v_cvt_pk_bf16_f32 v32, v25, v25
v_and_b32 v32, s35, v32
v_add_f32 v32, 0x3727c5ac, v32
v_cvt_pk_bf16_f32 v32, v32, v32
v_and_b32 v32, s35, v32
v_sqrt_f32 v32, v32
s_nop 0
v_cvt_pk_bf16_f32 v32, v32, v32
v_and_b32 v32, s35, v32
v_rcp_f32 v32, v32
s_nop 0
v_mul_f32 v34, v25, v32
v_mul_f32 v34, v34, v32
v_cvt_pk_bf16_f32 v34, v34, v34
v_and_b32 v34, s35, v34
v_add_f32 v34, 0x3727c5ac, v34
v_cvt_pk_bf16_f32 v34, v34, v34
v_and_b32 v34, s35, v34
v_sqrt_f32 v34, v34
s_nop 0
v_cvt_pk_bf16_f32 v34, v34, v34
v_and_b32 v34, s35, v34
v_rcp_f32 v34, v34
s_nop 0
v_mul_f32 v34, v34, v32
v_mul_f32 v33, v33, v32
v_mul_f32 v35, v24, v34
s_lshl_b32 s52, s26, 5
s_add_u32 s52, s52, 151616
v_add_u32 v28, s52, v7
s_mov_b64 exec, 3
ds_write_b128 v28, v[32:35]
s_mov_b64 exec, -1
s_waitcnt lgkmcnt(0)
v_mov_b32 v87, 0xf149f2ca
v_lshl_add_u32 v84, v9, 2, 0
v_sub_u32 v84, v8, v84
v_and_b32 v85, 1, v84
v_cmp_eq_u32 vcc, 0, v85
v_cmp_le_i32 s[52:53], 0, v84
v_mov_b32 v86, 0xffff
s_nop 0
s_and_b64 s[54:55], vcc, s[52:53]
s_andn2_b64 s[58:59], vcc, s[52:53]
v_cndmask_b32 v16, v87, 0, s[54:55]
v_cndmask_b32 v20, v87, 0, s[58:59]
v_cndmask_b32 v28, 0, v86, s[54:55]
v_cndmask_b32 v30, 0, v86, s[58:59]
v_lshl_add_u32 v84, v9, 2, 1
v_sub_u32 v84, v8, v84
v_and_b32 v85, 1, v84
v_cmp_eq_u32 vcc, 0, v85
v_cmp_le_i32 s[52:53], 0, v84
v_mov_b32 v86, 0xffff0000
s_nop 0
s_and_b64 s[54:55], vcc, s[52:53]
s_andn2_b64 s[58:59], vcc, s[52:53]
v_cndmask_b32 v17, v87, 0, s[54:55]
v_cndmask_b32 v21, v87, 0, s[58:59]
v_cndmask_b32 v28, v28, v86, s[54:55]
v_cndmask_b32 v30, v30, v86, s[58:59]
v_lshl_add_u32 v84, v9, 2, 2
v_sub_u32 v84, v8, v84
v_and_b32 v85, 1, v84
v_cmp_eq_u32 vcc, 0, v85
v_cmp_le_i32 s[52:53], 0, v84
v_mov_b32 v86, 0xffff
s_nop 0
s_and_b64 s[54:55], vcc, s[52:53]
s_andn2_b64 s[58:59], vcc, s[52:53]
v_cndmask_b32 v18, v87, 0, s[54:55]
v_cndmask_b32 v22, v87, 0, s[58:59]
v_cndmask_b32 v29, 0, v86, s[54:55]
v_cndmask_b32 v31, 0, v86, s[58:59]
v_lshl_add_u32 v84, v9, 2, 3
v_sub_u32 v84, v8, v84
v_and_b32 v85, 1, v84
v_cmp_eq_u32 vcc, 0, v85
v_cmp_le_i32 s[52:53], 0, v84
v_mov_b32 v86, 0xffff0000
s_nop 0
s_and_b64 s[54:55], vcc, s[52:53]
s_andn2_b64 s[58:59], vcc, s[52:53]
v_cndmask_b32 v19, v87, 0, s[54:55]
v_cndmask_b32 v23, v87, 0, s[58:59]
v_cndmask_b32 v29, v29, v86, s[54:55]
v_cndmask_b32 v31, v31, v86, s[58:59]
s_cmp_eq_u32 s27, 0
s_cselect_b64 vcc, -1, 0
v_cndmask_b32 v24, v20, v87, vcc
v_cndmask_b32 v25, v21, v87, vcc
v_cndmask_b32 v26, v22, v87, vcc
v_cndmask_b32 v27, v23, v87, vcc
s_barrier
v_add_u32 v12, s56, v10
v_add_u32 v14, s56, v13
ds_read_b64_tr_b16 v[104:105], v14 offset:0
ds_read_b64_tr_b16 v[106:107], v14 offset:512
ds_read_b64_tr_b16 v[108:109], v14 offset:8192
ds_read_b64_tr_b16 v[110:111], v14 offset:8704
ds_read_b64_tr_b16 v[112:113], v14 offset:16384
ds_read_b64_tr_b16 v[114:115], v14 offset:16896
ds_read_b128 v[32:35], v12 offset:0
ds_read_b128 v[36:39], v12 offset:2048
ds_read_b128 v[40:43], v12 offset:4096
ds_read_b128 v[44:47], v12 offset:6144
ds_read_b128 v[48:51], v12 offset:8192
ds_read_b128 v[52:55], v12 offset:10240
ds_read_b128 v[56:59], v12 offset:12288
ds_read_b128 v[60:63], v12 offset:14336
ds_read_b128 v[64:67], v12 offset:16384
s_waitcnt lgkmcnt(0)
L_cloopA:
v_mfma_f32_16x16x32_bf16 v[160:163], v[108:111], v[32:35], v[160:163]
v_add_u32 v12, s56, v11
v_mfma_f32_16x16x32_bf16 v[196:199], v[32:35], v[112:115], v[196:199]
ds_read_b64_tr_b16 v[116:117], v14 offset:4096
v_mfma_f32_16x16x32_bf16 v[164:167], v[108:111], v[36:39], v[164:167]
ds_read_b64_tr_b16 v[118:119], v14 offset:4608
v_mfma_f32_16x16x32_bf16 v[200:203], v[36:39], v[112:115], v[200:203]
ds_read_b64_tr_b16 v[120:121], v14 offset:12288
v_mfma_f32_16x16x32_bf16 v[128:131], v[104:107], v[36:39], v[128:131]
ds_read_b64_tr_b16 v[122:123], v14 offset:12800
v_mfma_f32_16x16x32_bf16 v[168:171], v[108:111], v[40:43], v[168:171]
ds_read_b64_tr_b16 v[124:125], v14 offset:20480
v_mfma_f32_16x16x32_bf16 v[204:207], v[40:43], v[112:115], v[204:207]
ds_read_b64_tr_b16 v[126:127], v14 offset:20992
v_mfma_f32_16x16x32_bf16 v[132:135], v[104:107], v[40:43], v[132:135]
ds_read_b128 v[68:71], v12 offset:0
v_mfma_f32_16x16x32_bf16 v[172:175], v[108:111], v[44:47], v[172:175]
ds_read_b128 v[72:75], v12 offset:2048
v_mfma_f32_16x16x32_bf16 v[208:211], v[44:47], v[112:115], v[208:211]
ds_read_b128 v[76:79], v12 offset:4096
v_mfma_f32_16x16x32_bf16 v[136:139], v[104:107], v[44:47], v[136:139]
ds_read_b128 v[80:83], v12 offset:6144
v_mfma_f32_16x16x32_bf16 v[176:179], v[108:111], v[48:51], v[176:179]
ds_read_b128 v[84:87], v12 offset:8192
v_mfma_f32_16x16x32_bf16 v[212:215], v[48:51], v[112:115], v[212:215]
ds_read_b128 v[88:91], v12 offset:10240
v_mfma_f32_16x16x32_bf16 v[140:143], v[104:107], v[48:51], v[140:143]
ds_read_b128 v[92:95], v12 offset:12288
v_mfma_f32_16x16x32_bf16 v[180:183], v[108:111], v[52:55], v[180:183]
ds_read_b128 v[96:99], v12 offset:14336
v_mfma_f32_16x16x32_bf16 v[216:219], v[52:55], v[112:115], v[216:219]
ds_read_b128 v[100:103], v12 offset:16384
v_mfma_f32_16x16x32_bf16 v[144:147], v[104:107], v[52:55], v[144:147]
v_mfma_f32_16x16x32_bf16 v[184:187], v[108:111], v[56:59], v[184:187]
v_mfma_f32_16x16x32_bf16 v[220:223], v[56:59], v[112:115], v[220:223]
v_mfma_f32_16x16x32_bf16 v[148:151], v[104:107], v[56:59], v[148:151]
v_mfma_f32_16x16x32_bf16 v[188:191], v[108:111], v[60:63], v[188:191]
v_mfma_f32_16x16x32_bf16 v[224:227], v[60:63], v[112:115], v[224:227]
v_mfma_f32_16x16x32_bf16 v[152:155], v[104:107], v[60:63], v[152:155]
v_mfma_f32_16x16x32_bf16 v[192:195], v[108:111], v[64:67], v[192:195]
v_mfma_f32_16x16x32_bf16 v[228:231], v[64:67], v[112:115], v[228:231]
v_mfma_f32_16x16x32_bf16 v[156:159], v[104:107], v[64:67], v[156:159]
v_mfma_f32_16x16x32_bf16 v[232:235], v[104:107], v[244:247], v[232:235]
v_mfma_f32_16x16x32_bf16 v[236:239], v[108:111], v[244:247], v[236:239]
v_mfma_f32_16x16x32_bf16 v[240:243], v[244:247], v[112:115], v[240:243]
s_waitcnt lgkmcnt(0)
s_barrier
v_mfma_f32_16x16x32_bf16 v[160:163], v[120:123], v[68:71], v[160:163]
s_add_u32 s56, s56, 43008
v_mfma_f32_16x16x32_bf16 v[196:199], v[68:71], v[124:127], v[196:199]
s_cmp_eq_u32 s56, 129024
v_mfma_f32_16x16x32_bf16 v[164:167], v[120:123], v[72:75], v[164:167]
s_cselect_b32 s56, 0, s56
v_mfma_f32_16x16x32_bf16 v[200:203], v[72:75], v[124:127], v[200:203]
v_add_u32 v12, s56, v10
v_mfma_f32_16x16x32_bf16 v[128:131], v[116:119], v[72:75], v[128:131]
v_add_u32 v14, s56, v13
v_mfma_f32_16x16x32_bf16 v[168:171], v[120:123], v[76:79], v[168:171]
ds_read_b64_tr_b16 v[104:105], v14 offset:0
v_mfma_f32_16x16x32_bf16 v[204:207], v[76:79], v[124:127], v[204:207]
ds_read_b64_tr_b16 v[106:107], v14 offset:512
v_mfma_f32_16x16x32_bf16 v[132:135], v[116:119], v[76:79], v[132:135]
ds_read_b64_tr_b16 v[108:109], v14 offset:8192
v_mfma_f32_16x16x32_bf16 v[172:175], v[120:123], v[80:83], v[172:175]
ds_read_b64_tr_b16 v[110:111], v14 offset:8704
v_mfma_f32_16x16x32_bf16 v[208:211], v[80:83], v[124:127], v[208:211]
ds_read_b64_tr_b16 v[112:113], v14 offset:16384
v_mfma_f32_16x16x32_bf16 v[136:139], v[116:119], v[80:83], v[136:139]
ds_read_b64_tr_b16 v[114:115], v14 offset:16896
v_mfma_f32_16x16x32_bf16 v[176:179], v[120:123], v[84:87], v[176:179]
ds_read_b128 v[32:35], v12 offset:0
v_mfma_f32_16x16x32_bf16 v[212:215], v[84:87], v[124:127], v[212:215]
ds_read_b128 v[36:39], v12 offset:2048
v_mfma_f32_16x16x32_bf16 v[140:143], v[116:119], v[84:87], v[140:143]
ds_read_b128 v[40:43], v12 offset:4096
v_mfma_f32_16x16x32_bf16 v[180:183], v[120:123], v[88:91], v[180:183]
ds_read_b128 v[44:47], v12 offset:6144
v_mfma_f32_16x16x32_bf16 v[216:219], v[88:91], v[124:127], v[216:219]
ds_read_b128 v[48:51], v12 offset:8192
v_mfma_f32_16x16x32_bf16 v[144:147], v[116:119], v[88:91], v[144:147]
ds_read_b128 v[52:55], v12 offset:10240
v_mfma_f32_16x16x32_bf16 v[184:187], v[120:123], v[92:95], v[184:187]
ds_read_b128 v[56:59], v12 offset:12288
v_mfma_f32_16x16x32_bf16 v[220:223], v[92:95], v[124:127], v[220:223]
ds_read_b128 v[60:63], v12 offset:14336
v_mfma_f32_16x16x32_bf16 v[148:151], v[116:119], v[92:95], v[148:151]
ds_read_b128 v[64:67], v12 offset:16384
v_mfma_f32_16x16x32_bf16 v[188:191], v[120:123], v[96:99], v[188:191]
v_mfma_f32_16x16x32_bf16 v[224:227], v[96:99], v[124:127], v[224:227]
v_mfma_f32_16x16x32_bf16 v[152:155], v[116:119], v[96:99], v[152:155]
v_mfma_f32_16x16x32_bf16 v[192:195], v[120:123], v[100:103], v[192:195]
v_mfma_f32_16x16x32_bf16 v[228:231], v[100:103], v[124:127], v[228:231]
v_mfma_f32_16x16x32_bf16 v[156:159], v[116:119], v[100:103], v[156:159]
v_mfma_f32_16x16x32_bf16 v[232:235], v[116:119], v[244:247], v[232:235]
v_mfma_f32_16x16x32_bf16 v[236:239], v[120:123], v[244:247], v[236:239]
v_mfma_f32_16x16x32_bf16 v[240:243], v[244:247], v[124:127], v[240:243]
s_add_u32 s57, s57, 1
s_cmp_lt_u32 s57, 8
s_waitcnt lgkmcnt(0)
s_cbranch_scc1 L_cloopA
s_waitcnt vmcnt(0)
s_nop 7
v_lshlrev_b32 v13, 2, v8
v_add_u32 v13, 131072, v13
v_lshlrev_b32 v14, 4, v9
v_add_u32 v14, 131072, v14
ds_read_b32 v32, v13 offset:0
ds_read_b32 v33, v13 offset:64
ds_read_b32 v34, v13 offset:128
ds_read_b32 v35, v13 offset:192
ds_read_b32 v36, v13 offset:256
ds_read_b32 v37, v13 offset:320
ds_read_b32 v38, v13 offset:384
ds_read_b32 v39, v13 offset:448
ds_read_b32 v40, v13 offset:512
ds_read_b128 v[52:55], v14 offset:0
ds_read_b128 v[88:91], v14 offset:576
ds_read_b128 v[56:59], v14 offset:64
ds_read_b128 v[92:95], v14 offset:640
ds_read_b128 v[60:63], v14 offset:128
ds_read_b128 v[96:99], v14 offset:704
s_waitcnt lgkmcnt(6)
ds_read_b32 v42, v13 offset:576
ds_read_b32 v43, v13 offset:640
ds_read_b32 v44, v13 offset:704
ds_read_b32 v45, v13 offset:768
ds_read_b32 v46, v13 offset:832
ds_read_b32 v47, v13 offset:896
ds_read_b32 v48, v13 offset:960
ds_read_b32 v49, v13 offset:1024
ds_read_b32 v50, v13 offset:1088
s_waitcnt lgkmcnt(3)
ds_read_b128 v[64:67], v14 offset:192
ds_read_b128 v[100:103], v14 offset:768
ds_read_b128 v[68:71], v14 offset:256
ds_read_b128 v[104:107], v14 offset:832
ds_read_b128 v[72:75], v14 offset:320
ds_read_b128 v[108:111], v14 offset:896
ds_read_b128 v[76:79], v14 offset:384
ds_read_b128 v[112:115], v14 offset:960
ds_read_b128 v[80:83], v14 offset:448
ds_read_b128 v[116:119], v14 offset:1024
ds_read_b128 v[84:87], v14 offset:512
ds_read_b128 v[120:123], v14 offset:1088
s_waitcnt lgkmcnt(12)
v_pk_mul_f32 v[4:5], v[236:237], v[42:43] op_sel:[0,0] op_sel_hi:[1,0]
v_pk_fma_f32 v[4:5], v[160:161], v[32:33], v[4:5] op_sel:[0,0,0] op_sel_hi:[1,0,1] neg_lo:[0,0,1] neg_hi:[0,0,1]
v_pk_mul_f32 v[6:7], v[238:239], v[42:43] op_sel:[0,0] op_sel_hi:[1,0]
v_pk_fma_f32 v[6:7], v[162:163], v[32:33], v[6:7] op_sel:[0,0,0] op_sel_hi:[1,0,1] neg_lo:[0,0,1] neg_hi:[0,0,1]
v_cvt_pk_bf16_f32 v160, v4, v5
v_cvt_pk_bf16_f32 v161, v6, v7
v_pk_mul_f32 v[4:5], v[236:237], v[42:43] op_sel:[0,1] op_sel_hi:[1,1]
v_pk_fma_f32 v[4:5], v[164:165], v[32:33], v[4:5] op_sel:[0,1,0] op_sel_hi:[1,1,1] neg_lo:[0,0,1] neg_hi:[0,0,1]
v_pk_mul_f32 v[6:7], v[238:239], v[42:43] op_sel:[0,1] op_sel_hi:[1,1]
v_pk_fma_f32 v[6:7], v[166:167], v[32:33], v[6:7] op_sel:[0,1,0] op_sel_hi:[1,1,1] neg_lo:[0,0,1] neg_hi:[0,0,1]
v_cvt_pk_bf16_f32 v162, v4, v5
v_cvt_pk_bf16_f32 v163, v6, v7
v_pk_mul_f32 v[4:5], v[232:233], v[42:43] op_sel:[0,1] op_sel_hi:[1,1]
v_pk_fma_f32 v[4:5], v[128:129], v[32:33], v[4:5] op_sel:[0,1,0] op_sel_hi:[1,1,1] neg_lo:[0,0,1] neg_hi:[0,0,1]
v_pk_mul_f32 v[6:7], v[234:235], v[42:43] op_sel:[0,1] op_sel_hi:[1,1]
v_pk_fma_f32 v[6:7], v[130:131], v[32:33], v[6:7] op_sel:[0,1,0] op_sel_hi:[1,1,1] neg_lo:[0,0,1] neg_hi:[0,0,1]
v_cvt_pk_bf16_f32 v128, v4, v5
v_cvt_pk_bf16_f32 v129, v6, v7
v_pk_mul_f32 v[4:5], v[236:237], v[44:45] op_sel:[0,0] op_sel_hi:[1,0]
v_pk_fma_f32 v[4:5], v[168:169], v[34:35], v[4:5] op_sel:[0,0,0] op_sel_hi:[1,0,1] neg_lo:[0,0,1] neg_hi:[0,0,1]
v_pk_mul_f32 v[6:7], v[238:239], v[44:45] op_sel:[0,0] op_sel_hi:[1,0]
v_pk_fma_f32 v[6:7], v[170:171], v[34:35], v[6:7] op_sel:[0,0,0] op_sel_hi:[1,0,1] neg_lo:[0,0,1] neg_hi:[0,0,1]
v_cvt_pk_bf16_f32 v164, v4, v5
v_cvt_pk_bf16_f32 v165, v6, v7
v_pk_mul_f32 v[4:5], v[232:233], v[44:45] op_sel:[0,0] op_sel_hi:[1,0]
v_pk_fma_f32 v[4:5], v[132:133], v[34:35], v[4:5] op_sel:[0,0,0] op_sel_hi:[1,0,1] neg_lo:[0,0,1] neg_hi:[0,0,1]
v_pk_mul_f32 v[6:7], v[234:235], v[44:45] op_sel:[0,0] op_sel_hi:[1,0]
v_pk_fma_f32 v[6:7], v[134:135], v[34:35], v[6:7] op_sel:[0,0,0] op_sel_hi:[1,0,1] neg_lo:[0,0,1] neg_hi:[0,0,1]
v_cvt_pk_bf16_f32 v130, v4, v5
v_cvt_pk_bf16_f32 v131, v6, v7
v_pk_mul_f32 v[4:5], v[236:237], v[44:45] op_sel:[0,1] op_sel_hi:[1,1]
v_pk_fma_f32 v[4:5], v[172:173], v[34:35], v[4:5] op_sel:[0,1,0] op_sel_hi:[1,1,1] neg_lo:[0,0,1] neg_hi:[0,0,1]
v_pk_mul_f32 v[6:7], v[238:239], v[44:45] op_sel:[0,1] op_sel_hi:[1,1]
v_pk_fma_f32 v[6:7], v[174:175], v[34:35], v[6:7] op_sel:[0,1,0] op_sel_hi:[1,1,1] neg_lo:[0,0,1] neg_hi:[0,0,1]
v_cvt_pk_bf16_f32 v166, v4, v5
v_cvt_pk_bf16_f32 v167, v6, v7
v_pk_mul_f32 v[4:5], v[232:233], v[44:45] op_sel:[0,1] op_sel_hi:[1,1]
v_pk_fma_f32 v[4:5], v[136:137], v[34:35], v[4:5] op_sel:[0,1,0] op_sel_hi:[1,1,1] neg_lo:[0,0,1] neg_hi:[0,0,1]
v_pk_mul_f32 v[6:7], v[234:235], v[44:45] op_sel:[0,1] op_sel_hi:[1,1]
v_pk_fma_f32 v[6:7], v[138:139], v[34:35], v[6:7] op_sel:[0,1,0] op_sel_hi:[1,1,1] neg_lo:[0,0,1] neg_hi:[0,0,1]
v_cvt_pk_bf16_f32 v132, v4, v5
v_cvt_pk_bf16_f32 v133, v6, v7
v_pk_mul_f32 v[4:5], v[236:237], v[46:47] op_sel:[0,0] op_sel_hi:[1,0]
v_pk_fma_f32 v[4:5], v[176:177], v[36:37], v[4:5] op_sel:[0,0,0] op_sel_hi:[1,0,1] neg_lo:[0,0,1] neg_hi:[0,0,1]
v_pk_mul_f32 v[6:7], v[238:239], v[46:47] op_sel:[0,0] op_sel_hi:[1,0]
v_pk_fma_f32 v[6:7], v[178:179], v[36:37], v[6:7] op_sel:[0,0,0] op_sel_hi:[1,0,1] neg_lo:[0,0,1] neg_hi:[0,0,1]
v_cvt_pk_bf16_f32 v168, v4, v5
v_cvt_pk_bf16_f32 v169, v6, v7
v_pk_mul_f32 v[4:5], v[232:233], v[46:47] op_sel:[0,0] op_sel_hi:[1,0]
v_pk_fma_f32 v[4:5], v[140:141], v[36:37], v[4:5] op_sel:[0,0,0] op_sel_hi:[1,0,1] neg_lo:[0,0,1] neg_hi:[0,0,1]
v_pk_mul_f32 v[6:7], v[234:235], v[46:47] op_sel:[0,0] op_sel_hi:[1,0]
v_pk_fma_f32 v[6:7], v[142:143], v[36:37], v[6:7] op_sel:[0,0,0] op_sel_hi:[1,0,1] neg_lo:[0,0,1] neg_hi:[0,0,1]
v_cvt_pk_bf16_f32 v134, v4, v5
v_cvt_pk_bf16_f32 v135, v6, v7
v_pk_mul_f32 v[4:5], v[236:237], v[46:47] op_sel:[0,1] op_sel_hi:[1,1]
v_pk_fma_f32 v[4:5], v[180:181], v[36:37], v[4:5] op_sel:[0,1,0] op_sel_hi:[1,1,1] neg_lo:[0,0,1] neg_hi:[0,0,1]
v_pk_mul_f32 v[6:7], v[238:239], v[46:47] op_sel:[0,1] op_sel_hi:[1,1]
v_pk_fma_f32 v[6:7], v[182:183], v[36:37], v[6:7] op_sel:[0,1,0] op_sel_hi:[1,1,1] neg_lo:[0,0,1] neg_hi:[0,0,1]
v_cvt_pk_bf16_f32 v170, v4, v5
v_cvt_pk_bf16_f32 v171, v6, v7
v_pk_mul_f32 v[4:5], v[232:233], v[46:47] op_sel:[0,1] op_sel_hi:[1,1]
v_pk_fma_f32 v[4:5], v[144:145], v[36:37], v[4:5] op_sel:[0,1,0] op_sel_hi:[1,1,1] neg_lo:[0,0,1] neg_hi:[0,0,1]
v_pk_mul_f32 v[6:7], v[234:235], v[46:47] op_sel:[0,1] op_sel_hi:[1,1]
v_pk_fma_f32 v[6:7], v[146:147], v[36:37], v[6:7] op_sel:[0,1,0] op_sel_hi:[1,1,1] neg_lo:[0,0,1] neg_hi:[0,0,1]
v_cvt_pk_bf16_f32 v136, v4, v5
v_cvt_pk_bf16_f32 v137, v6, v7
v_pk_mul_f32 v[4:5], v[236:237], v[48:49] op_sel:[0,0] op_sel_hi:[1,0]
v_pk_fma_f32 v[4:5], v[184:185], v[38:39], v[4:5] op_sel:[0,0,0] op_sel_hi:[1,0,1] neg_lo:[0,0,1] neg_hi:[0,0,1]
v_pk_mul_f32 v[6:7], v[238:239], v[48:49] op_sel:[0,0] op_sel_hi:[1,0]
v_pk_fma_f32 v[6:7], v[186:187], v[38:39], v[6:7] op_sel:[0,0,0] op_sel_hi:[1,0,1] neg_lo:[0,0,1] neg_hi:[0,0,1]
v_cvt_pk_bf16_f32 v172, v4, v5
v_cvt_pk_bf16_f32 v173, v6, v7
v_pk_mul_f32 v[4:5], v[232:233], v[48:49] op_sel:[0,0] op_sel_hi:[1,0]
v_pk_fma_f32 v[4:5], v[148:149], v[38:39], v[4:5] op_sel:[0,0,0] op_sel_hi:[1,0,1] neg_lo:[0,0,1] neg_hi:[0,0,1]
v_pk_mul_f32 v[6:7], v[234:235], v[48:49] op_sel:[0,0] op_sel_hi:[1,0]
v_pk_fma_f32 v[6:7], v[150:151], v[38:39], v[6:7] op_sel:[0,0,0] op_sel_hi:[1,0,1] neg_lo:[0,0,1] neg_hi:[0,0,1]
v_cvt_pk_bf16_f32 v138, v4, v5
v_cvt_pk_bf16_f32 v139, v6, v7
v_pk_mul_f32 v[4:5], v[236:237], v[48:49] op_sel:[0,1] op_sel_hi:[1,1]
v_pk_fma_f32 v[4:5], v[188:189], v[38:39], v[4:5] op_sel:[0,1,0] op_sel_hi:[1,1,1] neg_lo:[0,0,1] neg_hi:[0,0,1]
v_pk_mul_f32 v[6:7], v[238:239], v[48:49] op_sel:[0,1] op_sel_hi:[1,1]
v_pk_fma_f32 v[6:7], v[190:191], v[38:39], v[6:7] op_sel:[0,1,0] op_sel_hi:[1,1,1] neg_lo:[0,0,1] neg_hi:[0,0,1]
v_cvt_pk_bf16_f32 v174, v4, v5
v_cvt_pk_bf16_f32 v175, v6, v7
v_pk_mul_f32 v[4:5], v[232:233], v[48:49] op_sel:[0,1] op_sel_hi:[1,1]
v_pk_fma_f32 v[4:5], v[152:153], v[38:39], v[4:5] op_sel:[0,1,0] op_sel_hi:[1,1,1] neg_lo:[0,0,1] neg_hi:[0,0,1]
v_pk_mul_f32 v[6:7], v[234:235], v[48:49] op_sel:[0,1] op_sel_hi:[1,1]
v_pk_fma_f32 v[6:7], v[154:155], v[38:39], v[6:7] op_sel:[0,1,0] op_sel_hi:[1,1,1] neg_lo:[0,0,1] neg_hi:[0,0,1]
v_cvt_pk_bf16_f32 v140, v4, v5
v_cvt_pk_bf16_f32 v141, v6, v7
v_pk_mul_f32 v[4:5], v[236:237], v[50:51] op_sel:[0,0] op_sel_hi:[1,0]
v_pk_fma_f32 v[4:5], v[192:193], v[40:41], v[4:5] op_sel:[0,0,0] op_sel_hi:[1,0,1] neg_lo:[0,0,1] neg_hi:[0,0,1]
v_pk_mul_f32 v[6:7], v[238:239], v[50:51] op_sel:[0,0] op_sel_hi:[1,0]
v_pk_fma_f32 v[6:7], v[194:195], v[40:41], v[6:7] op_sel:[0,0,0] op_sel_hi:[1,0,1] neg_lo:[0,0,1] neg_hi:[0,0,1]
v_cvt_pk_bf16_f32 v176, v4, v5
v_cvt_pk_bf16_f32 v177, v6, v7
v_pk_mul_f32 v[4:5], v[232:233], v[50:51] op_sel:[0,0] op_sel_hi:[1,0]
v_pk_fma_f32 v[4:5], v[156:157], v[40:41], v[4:5] op_sel:[0,0,0] op_sel_hi:[1,0,1] neg_lo:[0,0,1] neg_hi:[0,0,1]
v_pk_mul_f32 v[6:7], v[234:235], v[50:51] op_sel:[0,0] op_sel_hi:[1,0]
v_pk_fma_f32 v[6:7], v[158:159], v[40:41], v[6:7] op_sel:[0,0,0] op_sel_hi:[1,0,1] neg_lo:[0,0,1] neg_hi:[0,0,1]
v_cvt_pk_bf16_f32 v142, v4, v5
v_cvt_pk_bf16_f32 v143, v6, v7
s_waitcnt lgkmcnt(0)
v_pk_mul_f32 v[4:5], v[88:89], v[240:241] op_sel:[0,0] op_sel_hi:[1,0]
v_pk_fma_f32 v[4:5], v[196:197], v[52:53], v[4:5] neg_lo:[0,0,1] neg_hi:[0,0,1]
v_pk_mul_f32 v[6:7], v[90:91], v[240:241] op_sel:[0,0] op_sel_hi:[1,0]
v_pk_fma_f32 v[6:7], v[198:199], v[54:55], v[6:7] neg_lo:[0,0,1] neg_hi:[0,0,1]
v_cvt_pk_bf16_f32 v196, v4, v5
v_cvt_pk_bf16_f32 v197, v6, v7
v_pk_mul_f32 v[4:5], v[92:93], v[240:241] op_sel:[0,0] op_sel_hi:[1,0]
v_pk_fma_f32 v[4:5], v[200:201], v[56:57], v[4:5] neg_lo:[0,0,1] neg_hi:[0,0,1]
v_pk_mul_f32 v[6:7], v[94:95], v[240:241] op_sel:[0,0] op_sel_hi:[1,0]
v_pk_fma_f32 v[6:7], v[202:203], v[58:59], v[6:7] neg_lo:[0,0,1] neg_hi:[0,0,1]
v_cvt_pk_bf16_f32 v198, v4, v5
v_cvt_pk_bf16_f32 v199, v6, v7
v_pk_mul_f32 v[4:5], v[96:97], v[240:241] op_sel:[0,0] op_sel_hi:[1,0]
v_pk_fma_f32 v[4:5], v[204:205], v[60:61], v[4:5] neg_lo:[0,0,1] neg_hi:[0,0,1]
v_pk_mul_f32 v[6:7], v[98:99], v[240:241] op_sel:[0,0] op_sel_hi:[1,0]
v_pk_fma_f32 v[6:7], v[206:207], v[62:63], v[6:7] neg_lo:[0,0,1] neg_hi:[0,0,1]
v_cvt_pk_bf16_f32 v200, v4, v5
v_cvt_pk_bf16_f32 v201, v6, v7
v_pk_mul_f32 v[4:5], v[100:101], v[240:241] op_sel:[0,0] op_sel_hi:[1,0]
v_pk_fma_f32 v[4:5], v[208:209], v[64:65], v[4:5] neg_lo:[0,0,1] neg_hi:[0,0,1]
v_pk_mul_f32 v[6:7], v[102:103], v[240:241] op_sel:[0,0] op_sel_hi:[1,0]
v_pk_fma_f32 v[6:7], v[210:211], v[66:67], v[6:7] neg_lo:[0,0,1] neg_hi:[0,0,1]
v_cvt_pk_bf16_f32 v202, v4, v5
v_cvt_pk_bf16_f32 v203, v6, v7
v_pk_mul_f32 v[4:5], v[104:105], v[240:241] op_sel:[0,0] op_sel_hi:[1,0]
v_pk_fma_f32 v[4:5], v[212:213], v[68:69], v[4:5] neg_lo:[0,0,1] neg_hi:[0,0,1]
v_pk_mul_f32 v[6:7], v[106:107], v[240:241] op_sel:[0,0] op_sel_hi:[1,0]
v_pk_fma_f32 v[6:7], v[214:215], v[70:71], v[6:7] neg_lo:[0,0,1] neg_hi:[0,0,1]
v_cvt_pk_bf16_f32 v204, v4, v5
v_cvt_pk_bf16_f32 v205, v6, v7
v_pk_mul_f32 v[4:5], v[108:109], v[240:241] op_sel:[0,0] op_sel_hi:[1,0]
v_pk_fma_f32 v[4:5], v[216:217], v[72:73], v[4:5] neg_lo:[0,0,1] neg_hi:[0,0,1]
v_pk_mul_f32 v[6:7], v[110:111], v[240:241] op_sel:[0,0] op_sel_hi:[1,0]
v_pk_fma_f32 v[6:7], v[218:219], v[74:75], v[6:7] neg_lo:[0,0,1] neg_hi:[0,0,1]
v_cvt_pk_bf16_f32 v206, v4, v5
v_cvt_pk_bf16_f32 v207, v6, v7
v_pk_mul_f32 v[4:5], v[112:113], v[240:241] op_sel:[0,0] op_sel_hi:[1,0]
v_pk_fma_f32 v[4:5], v[220:221], v[76:77], v[4:5] neg_lo:[0,0,1] neg_hi:[0,0,1]
v_pk_mul_f32 v[6:7], v[114:115], v[240:241] op_sel:[0,0] op_sel_hi:[1,0]
v_pk_fma_f32 v[6:7], v[222:223], v[78:79], v[6:7] neg_lo:[0,0,1] neg_hi:[0,0,1]
v_cvt_pk_bf16_f32 v208, v4, v5
v_cvt_pk_bf16_f32 v209, v6, v7
v_pk_mul_f32 v[4:5], v[116:117], v[240:241] op_sel:[0,0] op_sel_hi:[1,0]
v_pk_fma_f32 v[4:5], v[224:225], v[80:81], v[4:5] neg_lo:[0,0,1] neg_hi:[0,0,1]
v_pk_mul_f32 v[6:7], v[118:119], v[240:241] op_sel:[0,0] op_sel_hi:[1,0]
v_pk_fma_f32 v[6:7], v[226:227], v[82:83], v[6:7] neg_lo:[0,0,1] neg_hi:[0,0,1]
v_cvt_pk_bf16_f32 v210, v4, v5
v_cvt_pk_bf16_f32 v211, v6, v7
v_pk_mul_f32 v[4:5], v[120:121], v[240:241] op_sel:[0,0] op_sel_hi:[1,0]
v_pk_fma_f32 v[4:5], v[228:229], v[84:85], v[4:5] neg_lo:[0,0,1] neg_hi:[0,0,1]
v_pk_mul_f32 v[6:7], v[122:123], v[240:241] op_sel:[0,0] op_sel_hi:[1,0]
v_pk_fma_f32 v[6:7], v[230:231], v[86:87], v[6:7] neg_lo:[0,0,1] neg_hi:[0,0,1]
v_cvt_pk_bf16_f32 v212, v4, v5
v_cvt_pk_bf16_f32 v213, v6, v7
s_mov_b32 s54, 0x3eb8aa3b
v_mfma_f32_16x16x16_bf16 v[88:91], v[160:161], v[128:129], v[24:27]
v_mfma_f32_16x16x16_bf16 v[92:95], v[162:163], v[128:129], v[16:19]
v_mfma_f32_16x16x16_bf16 v[96:99], v[162:163], v[130:131], v[20:23]
v_mfma_f32_16x16x16_bf16 v[100:103], v[164:165], v[130:131], v[16:19]
v_mfma_f32_16x16x16_bf16 v[104:107], v[164:165], v[132:133], v[20:23]
v_mfma_f32_16x16x16_bf16 v[108:111], v[166:167], v[132:133], v[16:19]
v_mfma_f32_16x16x16_bf16 v[112:115], v[166:167], v[134:135], v[20:23]
v_mfma_f32_16x16x16_bf16 v[116:119], v[168:169], v[134:135], v[16:19]
s_nop 3
v_max3_f32 v144, v88, v89, v92
v_max3_f32 v145, v90, v91, v94
v_max_f32 v144, v144, v93
v_max_f32 v145, v145, v95
v_max_f32 v146, v144, v145
v_max3_f32 v148, v96, v97, v100
v_max3_f32 v149, v98, v99, v102
v_max_f32 v148, v148, v101
v_max_f32 v149, v149, v103
v_max_f32 v150, v148, v149
v_max3_f32 v152, v104, v105, v108
v_max3_f32 v153, v106, v107, v110
v_max_f32 v152, v152, v109
v_max_f32 v153, v153, v111
v_max_f32 v154, v152, v153
v_max3_f32 v156, v112, v113, v116
v_max3_f32 v157, v114, v115, v118
v_max_f32 v156, v156, v117
v_max_f32 v157, v157, v119
v_max_f32 v158, v156, v157
v_mov_b32 v147, v146
v_mov_b32 v151, v150
v_mov_b32 v155, v154
v_mov_b32 v159, v158
v_permlane16_swap_b32 v146, v147
v_permlane16_swap_b32 v150, v151
v_permlane16_swap_b32 v154, v155
v_permlane16_swap_b32 v158, v159
v_max_f32 v146, v146, v147
v_max_f32 v150, v150, v151
v_max_f32 v154, v154, v155
v_max_f32 v158, v158, v159
v_mov_b32 v147, v146
v_mov_b32 v151, v150
v_mov_b32 v155, v154
v_mov_b32 v159, v158
v_permlane32_swap_b32 v146, v147
v_permlane32_swap_b32 v150, v151
v_permlane32_swap_b32 v154, v155
v_permlane32_swap_b32 v158, v159
v_max_f32 v146, v146, v147
v_max_f32 v150, v150, v151
v_max_f32 v154, v154, v155
v_max_f32 v158, v158, v159
v_mul_f32 v146, s54, v146
v_mul_f32 v150, s54, v150
v_mul_f32 v154, s54, v154
v_mul_f32 v158, s54, v158
v_fma_f32 v144, v144, s54, -v146
v_fma_f32 v145, v145, s54, -v146
v_fma_f32 v148, v148, s54, -v150
v_fma_f32 v149, v149, s54, -v150
v_fma_f32 v152, v152, s54, -v154
v_fma_f32 v153, v153, s54, -v154
v_fma_f32 v156, v156, s54, -v158
v_fma_f32 v157, v157, s54, -v158
v_exp_f32 v144, v144
v_exp_f32 v145, v145
v_exp_f32 v148, v148
v_exp_f32 v149, v149
v_exp_f32 v152, v152
v_exp_f32 v153, v153
v_exp_f32 v156, v156
v_exp_f32 v157, v157
v_cvt_pk_bf16_f32 v144, v144, v144
v_cvt_pk_bf16_f32 v145, v145, v145
v_cvt_pk_bf16_f32 v148, v148, v148
v_cvt_pk_bf16_f32 v149, v149, v149
v_cvt_pk_bf16_f32 v152, v152, v152
v_cvt_pk_bf16_f32 v153, v153, v153
v_cvt_pk_bf16_f32 v156, v156, v156
v_cvt_pk_bf16_f32 v157, v157, v157
v_and_b32 v178, v144, v30
v_and_b32 v179, v145, v31
v_and_b32 v180, v144, v28
v_and_b32 v181, v145, v29
v_and_b32 v182, v148, v30
v_and_b32 v183, v149, v31
v_and_b32 v184, v148, v28
v_and_b32 v185, v149, v29
v_and_b32 v186, v152, v30
v_and_b32 v187, v153, v31
v_and_b32 v188, v152, v28
v_and_b32 v189, v153, v29
v_and_b32 v190, v156, v30
v_and_b32 v191, v157, v31
v_and_b32 v192, v156, v28
v_and_b32 v193, v157, v29
s_nop 1
v_mfma_f32_16x16x32_bf16 v[88:91], v[244:247], v[178:181], 0
v_mfma_f32_16x16x32_bf16 v[92:95], v[196:199], v[178:181], 0
v_mfma_f32_16x16x32_bf16 v[96:99], v[244:247], v[182:185], 0
v_mfma_f32_16x16x32_bf16 v[100:103], v[198:201], v[182:185], 0
v_mfma_f32_16x16x32_bf16 v[104:107], v[244:247], v[186:189], 0
v_mfma_f32_16x16x32_bf16 v[108:111], v[200:203], v[186:189], 0
v_mfma_f32_16x16x32_bf16 v[112:115], v[244:247], v[190:193], 0
v_mfma_f32_16x16x32_bf16 v[116:119], v[202:205], v[190:193], 0
s_nop 3
v_rcp_f32 v88, v88
v_rcp_f32 v96, v96
v_rcp_f32 v104, v104
v_rcp_f32 v112, v112
v_mul_f32 v92, v92, v88
v_mul_f32 v93, v93, v88
v_mul_f32 v94, v94, v88
v_mul_f32 v95, v95, v88
v_mul_f32 v100, v100, v96
v_mul_f32 v101, v101, v96
v_mul_f32 v102, v102, v96
v_mul_f32 v103, v103, v96
v_mul_f32 v108, v108, v104
v_mul_f32 v109, v109, v104
v_mul_f32 v110, v110, v104
v_mul_f32 v111, v111, v104
v_mul_f32 v116, v116, v112
v_mul_f32 v117, v117, v112
v_mul_f32 v118, v118, v112
v_mul_f32 v119, v119, v112
v_cvt_pk_bf16_f32 v214, v92, v93
v_cvt_pk_bf16_f32 v215, v94, v95
v_cvt_pk_bf16_f32 v216, v100, v101
v_cvt_pk_bf16_f32 v217, v102, v103
v_cvt_pk_bf16_f32 v218, v108, v109
v_cvt_pk_bf16_f32 v219, v110, v111
v_cvt_pk_bf16_f32 v220, v116, v117
v_cvt_pk_bf16_f32 v221, v118, v119
v_mfma_f32_16x16x16_bf16 v[88:91], v[168:169], v[136:137], v[20:23]
v_mfma_f32_16x16x16_bf16 v[92:95], v[170:171], v[136:137], v[16:19]
v_mfma_f32_16x16x16_bf16 v[96:99], v[170:171], v[138:139], v[20:23]
v_mfma_f32_16x16x16_bf16 v[100:103], v[172:173], v[138:139], v[16:19]
v_mfma_f32_16x16x16_bf16 v[104:107], v[172:173], v[140:141], v[20:23]
v_mfma_f32_16x16x16_bf16 v[108:111], v[174:175], v[140:141], v[16:19]
v_mfma_f32_16x16x16_bf16 v[112:115], v[174:175], v[142:143], v[20:23]
v_mfma_f32_16x16x16_bf16 v[116:119], v[176:177], v[142:143], v[16:19]
s_nop 3
v_max3_f32 v144, v88, v89, v92
v_max3_f32 v145, v90, v91, v94
v_max_f32 v144, v144, v93
v_max_f32 v145, v145, v95
v_max_f32 v146, v144, v145
v_max3_f32 v148, v96, v97, v100
v_max3_f32 v149, v98, v99, v102
v_max_f32 v148, v148, v101
v_max_f32 v149, v149, v103
v_max_f32 v150, v148, v149
v_max3_f32 v152, v104, v105, v108
v_max3_f32 v153, v106, v107, v110
v_max_f32 v152, v152, v109
v_max_f32 v153, v153, v111
v_max_f32 v154, v152, v153
v_max3_f32 v156, v112, v113, v116
v_max3_f32 v157, v114, v115, v118
v_max_f32 v156, v156, v117
v_max_f32 v157, v157, v119
v_max_f32 v158, v156, v157
v_mov_b32 v147, v146
v_mov_b32 v151, v150
v_mov_b32 v155, v154
v_mov_b32 v159, v158
v_permlane16_swap_b32 v146, v147
v_permlane16_swap_b32 v150, v151
v_permlane16_swap_b32 v154, v155
v_permlane16_swap_b32 v158, v159
v_max_f32 v146, v146, v147
v_max_f32 v150, v150, v151
v_max_f32 v154, v154, v155
v_max_f32 v158, v158, v159
v_mov_b32 v147, v146
v_mov_b32 v151, v150
v_mov_b32 v155, v154
v_mov_b32 v159, v158
v_permlane32_swap_b32 v146, v147
v_permlane32_swap_b32 v150, v151
v_permlane32_swap_b32 v154, v155
v_permlane32_swap_b32 v158, v159
v_max_f32 v146, v146, v147
v_max_f32 v150, v150, v151
v_max_f32 v154, v154, v155
v_max_f32 v158, v158, v159
v_mul_f32 v146, s54, v146
v_mul_f32 v150, s54, v150
v_mul_f32 v154, s54, v154
v_mul_f32 v158, s54, v158
v_fma_f32 v144, v144, s54, -v146
v_fma_f32 v145, v145, s54, -v146
v_fma_f32 v148, v148, s54, -v150
v_fma_f32 v149, v149, s54, -v150
v_fma_f32 v152, v152, s54, -v154
v_fma_f32 v153, v153, s54, -v154
v_fma_f32 v156, v156, s54, -v158
v_fma_f32 v157, v157, s54, -v158
v_exp_f32 v144, v144
v_exp_f32 v145, v145
v_exp_f32 v148, v148
v_exp_f32 v149, v149
v_exp_f32 v152, v152
v_exp_f32 v153, v153
v_exp_f32 v156, v156
v_exp_f32 v157, v157
v_cvt_pk_bf16_f32 v144, v144, v144
v_cvt_pk_bf16_f32 v145, v145, v145
v_cvt_pk_bf16_f32 v148, v148, v148
v_cvt_pk_bf16_f32 v149, v149, v149
v_cvt_pk_bf16_f32 v152, v152, v152
v_cvt_pk_bf16_f32 v153, v153, v153
v_cvt_pk_bf16_f32 v156, v156, v156
v_cvt_pk_bf16_f32 v157, v157, v157
v_and_b32 v178, v144, v30
v_and_b32 v179, v145, v31
v_and_b32 v180, v144, v28
v_and_b32 v181, v145, v29
v_and_b32 v182, v148, v30
v_and_b32 v183, v149, v31
v_and_b32 v184, v148, v28
v_and_b32 v185, v149, v29
v_and_b32 v186, v152, v30
v_and_b32 v187, v153, v31
v_and_b32 v188, v152, v28
v_and_b32 v189, v153, v29
v_and_b32 v190, v156, v30
v_and_b32 v191, v157, v31
v_and_b32 v192, v156, v28
v_and_b32 v193, v157, v29
s_nop 1
v_mfma_f32_16x16x32_bf16 v[88:91], v[244:247], v[178:181], 0
v_mfma_f32_16x16x32_bf16 v[92:95], v[204:207], v[178:181], 0
v_mfma_f32_16x16x32_bf16 v[96:99], v[244:247], v[182:185], 0
v_mfma_f32_16x16x32_bf16 v[100:103], v[206:209], v[182:185], 0
v_mfma_f32_16x16x32_bf16 v[104:107], v[244:247], v[186:189], 0
v_mfma_f32_16x16x32_bf16 v[108:111], v[208:211], v[186:189], 0
v_mfma_f32_16x16x32_bf16 v[112:115], v[244:247], v[190:193], 0
v_mfma_f32_16x16x32_bf16 v[116:119], v[210:213], v[190:193], 0
s_nop 3
v_rcp_f32 v88, v88
v_rcp_f32 v96, v96
v_rcp_f32 v104, v104
v_rcp_f32 v112, v112
v_mul_f32 v92, v92, v88
v_mul_f32 v93, v93, v88
v_mul_f32 v94, v94, v88
v_mul_f32 v95, v95, v88
v_mul_f32 v100, v100, v96
v_mul_f32 v101, v101, v96
v_mul_f32 v102, v102, v96
v_mul_f32 v103, v103, v96
v_mul_f32 v108, v108, v104
v_mul_f32 v109, v109, v104
v_mul_f32 v110, v110, v104
v_mul_f32 v111, v111, v104
v_mul_f32 v116, v116, v112
v_mul_f32 v117, v117, v112
v_mul_f32 v118, v118, v112
v_mul_f32 v119, v119, v112
v_cvt_pk_bf16_f32 v222, v92, v93
v_cvt_pk_bf16_f32 v223, v94, v95
v_cvt_pk_bf16_f32 v224, v100, v101
v_cvt_pk_bf16_f32 v225, v102, v103
v_cvt_pk_bf16_f32 v226, v108, v109
v_cvt_pk_bf16_f32 v227, v110, v111
v_cvt_pk_bf16_f32 v228, v116, v117
v_cvt_pk_bf16_f32 v229, v118, v119
s_lshr_b32 s52, s26, 1
s_lshl_b32 s52, s52, 13
s_add_u32 s52, s52, 135168
s_and_b32 s53, s26, 1
s_lshl_b32 s54, s53, 3
s_add_u32 s54, s54, s52
v_lshlrev_b32 v15, 4, v0
v_add_u32 v2, s54, v15
ds_write_b64 v2, v[214:215] offset:0
ds_write_b64 v2, v[216:217] offset:1024
ds_write_b64 v2, v[218:219] offset:2048
ds_write_b64 v2, v[220:221] offset:3072
ds_write_b64 v2, v[222:223] offset:4096
ds_write_b64 v2, v[224:225] offset:5120
ds_write_b64 v2, v[226:227] offset:6144
ds_write_b64 v2, v[228:229] offset:7168
s_lshl_b32 s54, s53, 12
s_add_u32 s54, s54, s52
s_lshr_b32 s55, s26, 1
s_lshl_b32 s55, s55, 2
s_add_u32 s55, s55, 151812
v_mov_b32 v2, s55
v_mov_b32 v3, 1
s_mov_b64 exec, 1
ds_add_u32 v2, v3
L_ls_xa:
ds_read_b32 v3, v2
s_waitcnt lgkmcnt(0)
v_readfirstlane_b32 s59, v3
s_nop 1
s_cmp_lt_u32 s59, 2
s_cbranch_scc1 L_ls_xa
s_mov_b64 exec, -1
v_add_u32 v3, s54, v15
ds_read_b128 v[88:91], v3 offset:0
ds_read_b128 v[92:95], v3 offset:1024
ds_read_b128 v[96:99], v3 offset:2048
ds_read_b128 v[100:103], v3 offset:3072
s_lshl_b32 s52, s27, 3
s_lshl_b32 s54, s53, 2
s_add_u32 s52, s52, s54
s_mul_i32 s52, s52, 60
s_lshl_b32 s54, s63, 1
s_add_u32 s52, s52, s54
s_lshr_b32 s54, s26, 1
s_add_u32 s52, s52, s54
s_lshl_b32 s52, s52, 10
s_waitcnt lgkmcnt(3)
buffer_store_dwordx4 v[88:91], v15, s[36:39], s52 offen sc1
s_add_u32 s52, s52, 61440
s_waitcnt lgkmcnt(2)
buffer_store_dwordx4 v[92:95], v15, s[36:39], s52 offen sc1
s_add_u32 s52, s52, 61440
s_waitcnt lgkmcnt(1)
buffer_store_dwordx4 v[96:99], v15, s[36:39], s52 offen sc1
s_add_u32 s52, s52, 61440
s_waitcnt lgkmcnt(0)
buffer_store_dwordx4 v[100:103], v15, s[36:39], s52 offen sc1
s_branch L_p1done
L_typeM:
v_and_b32 v8, 15, v0
v_lshrrev_b32 v9, 4, v0
v_lshrrev_b32 v2, 1, v8
v_xor_b32 v2, v2, v9
v_lshlrev_b32 v2, 4, v2
v_lshl_add_u32 v10, v8, 7, v2
v_lshrrev_b32 v2, 2, v8
v_lshl_add_u32 v2, v9, 3, v2
v_lshlrev_b32 v2, 7, v2
v_and_b32 v3, 3, v8
v_lshl_add_u32 v2, v3, 3, v2
v_add_u32 v2, 18432, v2
v_bfe_u32 v3, v8, 3, 1
v_and_b32 v1, 1, v9
v_lshl_add_u32 v3, v1, 1, v3
v_lshlrev_b32 v3, 5, v3
v_mov_b32 v244, 0x3f803f80
v_mov_b32 v245, 0x3f803f80
v_mov_b32 v246, 0x3f803f80
v_mov_b32 v247, 0x3f803f80
s_lshr_b32 s52, s26, 1
s_lshl_b32 s52, s52, 13
s_add_u32 s52, s52, 2048
v_add_u32 v10, s52, v10
v_xor_b32 v11, 64, v10
v_xor_b32 v1, 0, v3
v_add_u32 v116, v2, v1
v_xor_b32 v1, 32, v3
v_add_u32 v117, v2, v1
v_xor_b32 v1, 64, v3
v_add_u32 v118, v2, v1
v_xor_b32 v1, 96, v3
v_add_u32 v119, v2, v1
v_mov_b32 v128, 0
v_mov_b32 v129, 0
v_mov_b32 v130, 0
v_mov_b32 v131, 0
v_mov_b32 v132, 0
v_mov_b32 v133, 0
v_mov_b32 v134, 0
v_mov_b32 v135, 0
v_mov_b32 v136, 0
v_mov_b32 v137, 0
v_mov_b32 v138, 0
v_mov_b32 v139, 0
v_mov_b32 v140, 0
v_mov_b32 v141, 0
v_mov_b32 v142, 0
v_mov_b32 v143, 0
v_mov_b32 v144, 0
v_mov_b32 v145, 0
v_mov_b32 v146, 0
v_mov_b32 v147, 0
v_mov_b32 v148, 0
v_mov_b32 v149, 0
v_mov_b32 v150, 0
v_mov_b32 v151, 0
v_mov_b32 v152, 0
v_mov_b32 v153, 0
v_mov_b32 v154, 0
v_mov_b32 v155, 0
v_mov_b32 v156, 0
v_mov_b32 v157, 0
v_mov_b32 v158, 0
v_mov_b32 v159, 0
v_mov_b32 v160, 0
v_mov_b32 v161, 0
v_mov_b32 v162, 0
v_mov_b32 v163, 0
v_mov_b32 v164, 0
v_mov_b32 v165, 0
v_mov_b32 v166, 0
v_mov_b32 v167, 0
v_mov_b32 v168, 0
v_mov_b32 v169, 0
v_mov_b32 v170, 0
v_mov_b32 v171, 0
v_mov_b32 v172, 0
v_mov_b32 v173, 0
v_mov_b32 v174, 0
v_mov_b32 v175, 0
v_mov_b32 v176, 0
v_mov_b32 v177, 0
v_mov_b32 v178, 0
v_mov_b32 v179, 0
v_mov_b32 v180, 0
v_mov_b32 v181, 0
v_mov_b32 v182, 0
v_mov_b32 v183, 0
v_mov_b32 v184, 0
v_mov_b32 v185, 0
v_mov_b32 v186, 0
v_mov_b32 v187, 0
v_mov_b32 v188, 0
v_mov_b32 v189, 0
v_mov_b32 v190, 0
v_mov_b32 v191, 0
v_mov_b32 v192, 0
v_mov_b32 v193, 0
v_mov_b32 v194, 0
v_mov_b32 v195, 0
v_mov_b32 v196, 0
v_mov_b32 v197, 0
v_mov_b32 v198, 0
v_mov_b32 v199, 0
v_mov_b32 v200, 0
v_mov_b32 v201, 0
v_mov_b32 v202, 0
v_mov_b32 v203, 0
v_mov_b32 v204, 0
v_mov_b32 v205, 0
v_mov_b32 v206, 0
v_mov_b32 v207, 0
v_mov_b32 v208, 0
v_mov_b32 v209, 0
v_mov_b32 v210, 0
v_mov_b32 v211, 0
v_mov_b32 v212, 0
v_mov_b32 v213, 0
v_mov_b32 v214, 0
v_mov_b32 v215, 0
v_mov_b32 v216, 0
v_mov_b32 v217, 0
v_mov_b32 v218, 0
v_mov_b32 v219, 0
v_mov_b32 v220, 0
v_mov_b32 v221, 0
v_mov_b32 v222, 0
v_mov_b32 v223, 0
v_mov_b32 v224, 0
v_mov_b32 v225, 0
v_mov_b32 v226, 0
v_mov_b32 v227, 0
v_mov_b32 v228, 0
v_mov_b32 v229, 0
v_mov_b32 v230, 0
v_mov_b32 v231, 0
v_mov_b32 v232, 0
v_mov_b32 v233, 0
v_mov_b32 v234, 0
v_mov_b32 v235, 0
v_mov_b32 v236, 0
v_mov_b32 v237, 0
v_mov_b32 v238, 0
v_mov_b32 v239, 0
v_mov_b32 v240, 0
v_mov_b32 v241, 0
v_mov_b32 v242, 0
v_mov_b32 v243, 0
s_mov_b32 s56, 0
s_mov_b32 s57, 0
s_mov_b32 s36, s24
s_and_b32 s37, s25, 0xffff
s_mov_b32 s38, 7864320
s_mov_b32 s39, 0x20000
s_mov_b32 s40, s14
s_and_b32 s41, s15, 0xffff
s_mov_b32 s42, 2752
s_mov_b32 s43, 0x20000
s_waitcnt vmcnt(2)
v_mov_b32 v24, 0
v_mov_b32 v25, 0
v_mov_b32 v26, 0
v_mov_b32 v27, 0
v_mov_b32 v28, 0x3f803f80
v_dot2c_f32_bf16 v24, v16, v28
v_dot2c_f32_bf16 v25, v16, v16
v_dot2c_f32_bf16 v26, v20, v28
v_dot2c_f32_bf16 v27, v20, v20
v_dot2c_f32_bf16 v24, v17, v28
v_dot2c_f32_bf16 v25, v17, v17
v_dot2c_f32_bf16 v26, v21, v28
v_dot2c_f32_bf16 v27, v21, v21
v_dot2c_f32_bf16 v24, v18, v28
v_dot2c_f32_bf16 v25, v18, v18
v_dot2c_f32_bf16 v26, v22, v28
v_dot2c_f32_bf16 v27, v22, v22
v_dot2c_f32_bf16 v24, v19, v28
v_dot2c_f32_bf16 v25, v19, v19
v_dot2c_f32_bf16 v26, v23, v28
v_dot2c_f32_bf16 v27, v23, v23
s_nop 1
v_add_f32_dpp v24, v24, v24 row_ror:8 row_mask:0xf bank_mask:0xf
v_add_f32_dpp v25, v25, v25 row_ror:8 row_mask:0xf bank_mask:0xf
v_add_f32_dpp v26, v26, v26 row_ror:8 row_mask:0xf bank_mask:0xf
v_add_f32_dpp v27, v27, v27 row_ror:8 row_mask:0xf bank_mask:0xf
v_add_f32_dpp v24, v24, v24 row_ror:4 row_mask:0xf bank_mask:0xf
v_add_f32_dpp v25, v25, v25 row_ror:4 row_mask:0xf bank_mask:0xf
v_add_f32_dpp v26, v26, v26 row_ror:4 row_mask:0xf bank_mask:0xf
v_add_f32_dpp v27, v27, v27 row_ror:4 row_mask:0xf bank_mask:0xf
v_add_f32_dpp v24, v24, v24 row_ror:2 row_mask:0xf bank_mask:0xf
v_add_f32_dpp v25, v25, v25 row_ror:2 row_mask:0xf bank_mask:0xf
v_add_f32_dpp v26, v26, v26 row_ror:2 row_mask:0xf bank_mask:0xf
v_add_f32_dpp v27, v27, v27 row_ror:2 row_mask:0xf bank_mask:0xf
v_add_f32_dpp v24, v24, v24 row_ror:1 row_mask:0xf bank_mask:0xf
v_add_f32_dpp v25, v25, v25 row_ror:1 row_mask:0xf bank_mask:0xf
v_add_f32_dpp v26, v26, v26 row_ror:1 row_mask:0xf bank_mask:0xf
v_add_f32_dpp v27, v27, v27 row_ror:1 row_mask:0xf bank_mask:0xf
v_mov_b32 v28, v24
v_mov_b32 v29, v25
v_mov_b32 v30, v26
v_mov_b32 v31, v27
v_permlane16_swap_b32 v24, v28
v_permlane16_swap_b32 v25, v29
v_permlane16_swap_b32 v26, v30
v_permlane16_swap_b32 v27, v31
v_add_f32 v24, v24, v28
v_add_f32 v25, v25, v29
v_add_f32 v26, v26, v30
v_add_f32 v27, v27, v31
v_mov_b32 v28, v24
v_mov_b32 v29, v25
v_mov_b32 v30, v26
v_mov_b32 v31, v27
v_permlane32_swap_b32 v24, v28
v_permlane32_swap_b32 v25, v29
v_permlane32_swap_b32 v26, v30
v_permlane32_swap_b32 v27, v31
v_add_f32 v24, v24, v28
v_add_f32 v25, v25, v29
v_add_f32 v26, v26, v30
v_add_f32 v27, v27, v31
v_and_b32 v28, 1, v0
v_cmp_eq_u32 vcc, 1, v28
s_nop 1
v_cndmask_b32 v24, v24, v26, vcc
v_cndmask_b32 v25, v25, v27, vcc
v_mul_f32 v24, 0x3b000000, v24
v_mul_f32 v25, 0x3b000000, v25
v_fma_f32 v25, -v24, v24, v25
v_max_f32 v25, 0, v25
v_cvt_pk_bf16_f32 v33, v24, v24
v_and_b32 v33, s35, v33
v_cvt_pk_bf16_f32 v32, v25, v25
v_and_b32 v32, s35, v32
v_add_f32 v32, 0x3727c5ac, v32
v_cvt_pk_bf16_f32 v32, v32, v32
v_and_b32 v32, s35, v32
v_sqrt_f32 v32, v32
s_nop 0
v_cvt_pk_bf16_f32 v32, v32, v32
v_and_b32 v32, s35, v32
v_rcp_f32 v32, v32
s_nop 0
v_mul_f32 v34, v25, v32
v_mul_f32 v34, v34, v32
v_cvt_pk_bf16_f32 v34, v34, v34
v_and_b32 v34, s35, v34
v_add_f32 v34, 0x3727c5ac, v34
v_cvt_pk_bf16_f32 v34, v34, v34
v_and_b32 v34, s35, v34
v_sqrt_f32 v34, v34
s_nop 0
v_cvt_pk_bf16_f32 v34, v34, v34
v_and_b32 v34, s35, v34
v_rcp_f32 v34, v34
s_nop 0
v_mul_f32 v34, v34, v32
v_mul_f32 v33, v33, v32
v_mul_f32 v35, v24, v34
s_lshl_b32 s52, s26, 5
s_add_u32 s52, s52, 151616
v_add_u32 v28, s52, v7
s_mov_b64 exec, 3
ds_write_b128 v28, v[32:35]
s_mov_b64 exec, -1
s_waitcnt lgkmcnt(0)
s_and_b32 s52, s26, 1
s_mul_i32 s52, s52, 3
s_add_u32 s52, s52, s29
s_lshl_b32 s52, s52, 6
v_lshlrev_b32 v2, 3, v9
buffer_load_dwordx2 v[16:17], v2, s[40:43], s52 offen offset:0
buffer_load_dwordx2 v[18:19], v2, s[40:43], s52 offen offset:32
buffer_load_dwordx2 v[20:21], v2, s[40:43], s52 offen offset:64
buffer_load_dwordx2 v[22:23], v2, s[40:43], s52 offen offset:96
buffer_load_dwordx2 v[24:25], v2, s[40:43], s52 offen offset:128
buffer_load_dwordx2 v[26:27], v2, s[40:43], s52 offen offset:160
s_cmp_eq_u32 s26, 1
s_cbranch_scc1 L_mv1
s_cmp_eq_u32 s26, 2
s_cbranch_scc1 L_mv2
s_cmp_eq_u32 s26, 3
s_cbranch_scc1 L_mv3
L_mv0:
s_barrier
v_add_u32 v12, s56, v10
v_add_u32 v112, s56, v116
v_add_u32 v113, s56, v117
v_add_u32 v114, s56, v118
v_add_u32 v115, s56, v119
ds_read_b64_tr_b16 v[64:65], v112 offset:0
ds_read_b64_tr_b16 v[66:67], v112 offset:512
ds_read_b64_tr_b16 v[68:69], v113 offset:0
ds_read_b64_tr_b16 v[70:71], v113 offset:512
ds_read_b64_tr_b16 v[72:73], v114 offset:0
ds_read_b64_tr_b16 v[74:75], v114 offset:512
ds_read_b64_tr_b16 v[76:77], v115 offset:0
ds_read_b64_tr_b16 v[78:79], v115 offset:512
ds_read_b64_tr_b16 v[80:81], v112 offset:8192
ds_read_b64_tr_b16 v[82:83], v112 offset:8704
ds_read_b64_tr_b16 v[84:85], v113 offset:8192
ds_read_b64_tr_b16 v[86:87], v113 offset:8704
ds_read_b128 v[32:35], v12 offset:0
ds_read_b128 v[36:39], v12 offset:2048
ds_read_b128 v[40:43], v12 offset:4096
ds_read_b128 v[44:47], v12 offset:6144
s_waitcnt lgkmcnt(0)
L_cloopM0:
v_mfma_f32_16x16x32_bf16 v[128:131], v[64:67], v[32:35], v[128:131]
v_add_u32 v12, s56, v11
v_mfma_f32_16x16x32_bf16 v[136:139], v[64:67], v[36:39], v[136:139]
ds_read_b64_tr_b16 v[88:89], v112 offset:4096
v_mfma_f32_16x16x32_bf16 v[144:147], v[64:67], v[40:43], v[144:147]
ds_read_b64_tr_b16 v[90:91], v112 offset:4608
v_mfma_f32_16x16x32_bf16 v[152:155], v[64:67], v[44:47], v[152:155]
ds_read_b64_tr_b16 v[92:93], v113 offset:4096
v_mfma_f32_16x16x32_bf16 v[132:135], v[68:71], v[32:35], v[132:135]
ds_read_b64_tr_b16 v[94:95], v113 offset:4608
v_mfma_f32_16x16x32_bf16 v[140:143], v[68:71], v[36:39], v[140:143]
ds_read_b64_tr_b16 v[96:97], v114 offset:4096
v_mfma_f32_16x16x32_bf16 v[148:151], v[68:71], v[40:43], v[148:151]
ds_read_b64_tr_b16 v[98:99], v114 offset:4608
v_mfma_f32_16x16x32_bf16 v[156:159], v[68:71], v[44:47], v[156:159]
ds_read_b64_tr_b16 v[100:101], v115 offset:4096
v_mfma_f32_16x16x32_bf16 v[160:163], v[72:75], v[32:35], v[160:163]
ds_read_b64_tr_b16 v[102:103], v115 offset:4608
v_mfma_f32_16x16x32_bf16 v[168:171], v[72:75], v[36:39], v[168:171]
ds_read_b64_tr_b16 v[104:105], v112 offset:12288
v_mfma_f32_16x16x32_bf16 v[176:179], v[72:75], v[40:43], v[176:179]
ds_read_b64_tr_b16 v[106:107], v112 offset:12800
v_mfma_f32_16x16x32_bf16 v[184:187], v[72:75], v[44:47], v[184:187]
ds_read_b64_tr_b16 v[108:109], v113 offset:12288
v_mfma_f32_16x16x32_bf16 v[164:167], v[76:79], v[32:35], v[164:167]
ds_read_b64_tr_b16 v[110:111], v113 offset:12800
v_mfma_f32_16x16x32_bf16 v[172:175], v[76:79], v[36:39], v[172:175]
ds_read_b128 v[48:51], v12 offset:0
v_mfma_f32_16x16x32_bf16 v[180:183], v[76:79], v[40:43], v[180:183]
ds_read_b128 v[52:55], v12 offset:2048
v_mfma_f32_16x16x32_bf16 v[188:191], v[76:79], v[44:47], v[188:191]
ds_read_b128 v[56:59], v12 offset:4096
v_mfma_f32_16x16x32_bf16 v[192:195], v[80:83], v[32:35], v[192:195]
ds_read_b128 v[60:63], v12 offset:6144
v_mfma_f32_16x16x32_bf16 v[200:203], v[80:83], v[36:39], v[200:203]
v_mfma_f32_16x16x32_bf16 v[208:211], v[80:83], v[40:43], v[208:211]
v_mfma_f32_16x16x32_bf16 v[216:219], v[80:83], v[44:47], v[216:219]
v_mfma_f32_16x16x32_bf16 v[196:199], v[84:87], v[32:35], v[196:199]
v_mfma_f32_16x16x32_bf16 v[204:207], v[84:87], v[36:39], v[204:207]
v_mfma_f32_16x16x32_bf16 v[212:215], v[84:87], v[40:43], v[212:215]
v_mfma_f32_16x16x32_bf16 v[220:223], v[84:87], v[44:47], v[220:223]
v_mfma_f32_16x16x32_bf16 v[232:235], v[64:67], v[244:247], v[232:235]
v_mfma_f32_16x16x32_bf16 v[236:239], v[68:71], v[244:247], v[236:239]
v_mfma_f32_16x16x32_bf16 v[240:243], v[72:75], v[244:247], v[240:243]
s_waitcnt lgkmcnt(0)
s_barrier
v_mfma_f32_16x16x32_bf16 v[128:131], v[88:91], v[48:51], v[128:131]
s_add_u32 s56, s56, 43008
v_mfma_f32_16x16x32_bf16 v[136:139], v[88:91], v[52:55], v[136:139]
s_cmp_eq_u32 s56, 129024
v_mfma_f32_16x16x32_bf16 v[144:147], v[88:91], v[56:59], v[144:147]
s_cselect_b32 s56, 0, s56
v_mfma_f32_16x16x32_bf16 v[152:155], v[88:91], v[60:63], v[152:155]
v_add_u32 v12, s56, v10
v_mfma_f32_16x16x32_bf16 v[132:135], v[92:95], v[48:51], v[132:135]
v_add_u32 v112, s56, v116
v_mfma_f32_16x16x32_bf16 v[140:143], v[92:95], v[52:55], v[140:143]
v_add_u32 v113, s56, v117
v_mfma_f32_16x16x32_bf16 v[148:151], v[92:95], v[56:59], v[148:151]
v_add_u32 v114, s56, v118
v_mfma_f32_16x16x32_bf16 v[156:159], v[92:95], v[60:63], v[156:159]
v_add_u32 v115, s56, v119
v_mfma_f32_16x16x32_bf16 v[160:163], v[96:99], v[48:51], v[160:163]
ds_read_b64_tr_b16 v[64:65], v112 offset:0
v_mfma_f32_16x16x32_bf16 v[168:171], v[96:99], v[52:55], v[168:171]
ds_read_b64_tr_b16 v[66:67], v112 offset:512
v_mfma_f32_16x16x32_bf16 v[176:179], v[96:99], v[56:59], v[176:179]
ds_read_b64_tr_b16 v[68:69], v113 offset:0
v_mfma_f32_16x16x32_bf16 v[184:187], v[96:99], v[60:63], v[184:187]
ds_read_b64_tr_b16 v[70:71], v113 offset:512
v_mfma_f32_16x16x32_bf16 v[164:167], v[100:103], v[48:51], v[164:167]
ds_read_b64_tr_b16 v[72:73], v114 offset:0
v_mfma_f32_16x16x32_bf16 v[172:175], v[100:103], v[52:55], v[172:175]
ds_read_b64_tr_b16 v[74:75], v114 offset:512
v_mfma_f32_16x16x32_bf16 v[180:183], v[100:103], v[56:59], v[180:183]
ds_read_b64_tr_b16 v[76:77], v115 offset:0
v_mfma_f32_16x16x32_bf16 v[188:191], v[100:103], v[60:63], v[188:191]
ds_read_b64_tr_b16 v[78:79], v115 offset:512
v_mfma_f32_16x16x32_bf16 v[192:195], v[104:107], v[48:51], v[192:195]
ds_read_b64_tr_b16 v[80:81], v112 offset:8192
v_mfma_f32_16x16x32_bf16 v[200:203], v[104:107], v[52:55], v[200:203]
ds_read_b64_tr_b16 v[82:83], v112 offset:8704
v_mfma_f32_16x16x32_bf16 v[208:211], v[104:107], v[56:59], v[208:211]
ds_read_b64_tr_b16 v[84:85], v113 offset:8192
v_mfma_f32_16x16x32_bf16 v[216:219], v[104:107], v[60:63], v[216:219]
ds_read_b64_tr_b16 v[86:87], v113 offset:8704
v_mfma_f32_16x16x32_bf16 v[196:199], v[108:111], v[48:51], v[196:199]
ds_read_b128 v[32:35], v12 offset:0
v_mfma_f32_16x16x32_bf16 v[204:207], v[108:111], v[52:55], v[204:207]
ds_read_b128 v[36:39], v12 offset:2048
v_mfma_f32_16x16x32_bf16 v[212:215], v[108:111], v[56:59], v[212:215]
ds_read_b128 v[40:43], v12 offset:4096
v_mfma_f32_16x16x32_bf16 v[220:223], v[108:111], v[60:63], v[220:223]
ds_read_b128 v[44:47], v12 offset:6144
v_mfma_f32_16x16x32_bf16 v[232:235], v[88:91], v[244:247], v[232:235]
v_mfma_f32_16x16x32_bf16 v[236:239], v[92:95], v[244:247], v[236:239]
v_mfma_f32_16x16x32_bf16 v[240:243], v[96:99], v[244:247], v[240:243]
s_add_u32 s57, s57, 1
s_cmp_lt_u32 s57, 8
s_waitcnt lgkmcnt(0)
s_cbranch_scc1 L_cloopM0
s_waitcnt vmcnt(0)
s_nop 7
v_lshlrev_b32 v2, 4, v9
v_add_u32 v2, 133376, v2
s_mov_b32 exec_lo, 0x00010001
s_mov_b32 exec_hi, 0x00010001
ds_write_b128 v2, v[232:235] offset:0
ds_write_b128 v2, v[236:239] offset:64
ds_write_b128 v2, v[240:243] offset:128
s_mov_b64 exec, -1
s_branch L_mepi
L_mv1:
s_barrier
v_add_u32 v12, s56, v10
v_add_u32 v112, s56, v116
v_add_u32 v113, s56, v117
v_add_u32 v114, s56, v118
v_add_u32 v115, s56, v119
ds_read_b64_tr_b16 v[64:65], v114 offset:8192
ds_read_b64_tr_b16 v[66:67], v114 offset:8704
ds_read_b64_tr_b16 v[68:69], v115 offset:8192
ds_read_b64_tr_b16 v[70:71], v115 offset:8704
ds_read_b64_tr_b16 v[72:73], v112 offset:16384
ds_read_b64_tr_b16 v[74:75], v112 offset:16896
ds_read_b64_tr_b16 v[76:77], v113 offset:16384
ds_read_b64_tr_b16 v[78:79], v113 offset:16896
ds_read_b64_tr_b16 v[80:81], v114 offset:16384
ds_read_b64_tr_b16 v[82:83], v114 offset:16896
ds_read_b64_tr_b16 v[84:85], v115 offset:16384
ds_read_b64_tr_b16 v[86:87], v115 offset:16896
ds_read_b128 v[32:35], v12 offset:0
ds_read_b128 v[36:39], v12 offset:2048
ds_read_b128 v[40:43], v12 offset:4096
ds_read_b128 v[44:47], v12 offset:6144
s_waitcnt lgkmcnt(0)
L_cloopM1:
v_mfma_f32_16x16x32_bf16 v[128:131], v[64:67], v[32:35], v[128:131]
v_add_u32 v12, s56, v11
v_mfma_f32_16x16x32_bf16 v[136:139], v[64:67], v[36:39], v[136:139]
ds_read_b64_tr_b16 v[88:89], v114 offset:12288
v_mfma_f32_16x16x32_bf16 v[144:147], v[64:67], v[40:43], v[144:147]
ds_read_b64_tr_b16 v[90:91], v114 offset:12800
v_mfma_f32_16x16x32_bf16 v[152:155], v[64:67], v[44:47], v[152:155]
ds_read_b64_tr_b16 v[92:93], v115 offset:12288
v_mfma_f32_16x16x32_bf16 v[132:135], v[68:71], v[32:35], v[132:135]
ds_read_b64_tr_b16 v[94:95], v115 offset:12800
v_mfma_f32_16x16x32_bf16 v[140:143], v[68:71], v[36:39], v[140:143]
ds_read_b64_tr_b16 v[96:97], v112 offset:20480
v_mfma_f32_16x16x32_bf16 v[148:151], v[68:71], v[40:43], v[148:151]
ds_read_b64_tr_b16 v[98:99], v112 offset:20992
v_mfma_f32_16x16x32_bf16 v[156:159], v[68:71], v[44:47], v[156:159]
ds_read_b64_tr_b16 v[100:101], v113 offset:20480
v_mfma_f32_16x16x32_bf16 v[160:163], v[72:75], v[32:35], v[160:163]
ds_read_b64_tr_b16 v[102:103], v113 offset:20992
v_mfma_f32_16x16x32_bf16 v[168:171], v[72:75], v[36:39], v[168:171]
ds_read_b64_tr_b16 v[104:105], v114 offset:20480
v_mfma_f32_16x16x32_bf16 v[176:179], v[72:75], v[40:43], v[176:179]
ds_read_b64_tr_b16 v[106:107], v114 offset:20992
v_mfma_f32_16x16x32_bf16 v[184:187], v[72:75], v[44:47], v[184:187]
ds_read_b64_tr_b16 v[108:109], v115 offset:20480
v_mfma_f32_16x16x32_bf16 v[164:167], v[76:79], v[32:35], v[164:167]
ds_read_b64_tr_b16 v[110:111], v115 offset:20992
v_mfma_f32_16x16x32_bf16 v[172:175], v[76:79], v[36:39], v[172:175]
ds_read_b128 v[48:51], v12 offset:0
v_mfma_f32_16x16x32_bf16 v[180:183], v[76:79], v[40:43], v[180:183]
ds_read_b128 v[52:55], v12 offset:2048
v_mfma_f32_16x16x32_bf16 v[188:191], v[76:79], v[44:47], v[188:191]
ds_read_b128 v[56:59], v12 offset:4096
v_mfma_f32_16x16x32_bf16 v[192:195], v[80:83], v[32:35], v[192:195]
ds_read_b128 v[60:63], v12 offset:6144
v_mfma_f32_16x16x32_bf16 v[200:203], v[80:83], v[36:39], v[200:203]
v_mfma_f32_16x16x32_bf16 v[208:211], v[80:83], v[40:43], v[208:211]
v_mfma_f32_16x16x32_bf16 v[216:219], v[80:83], v[44:47], v[216:219]
v_mfma_f32_16x16x32_bf16 v[196:199], v[84:87], v[32:35], v[196:199]
v_mfma_f32_16x16x32_bf16 v[204:207], v[84:87], v[36:39], v[204:207]
v_mfma_f32_16x16x32_bf16 v[212:215], v[84:87], v[40:43], v[212:215]
v_mfma_f32_16x16x32_bf16 v[220:223], v[84:87], v[44:47], v[220:223]
v_mfma_f32_16x16x32_bf16 v[232:235], v[64:67], v[244:247], v[232:235]
v_mfma_f32_16x16x32_bf16 v[236:239], v[68:71], v[244:247], v[236:239]
v_mfma_f32_16x16x32_bf16 v[240:243], v[72:75], v[244:247], v[240:243]
s_waitcnt lgkmcnt(0)
s_barrier
v_mfma_f32_16x16x32_bf16 v[128:131], v[88:91], v[48:51], v[128:131]
s_add_u32 s56, s56, 43008
v_mfma_f32_16x16x32_bf16 v[136:139], v[88:91], v[52:55], v[136:139]
s_cmp_eq_u32 s56, 129024
v_mfma_f32_16x16x32_bf16 v[144:147], v[88:91], v[56:59], v[144:147]
s_cselect_b32 s56, 0, s56
v_mfma_f32_16x16x32_bf16 v[152:155], v[88:91], v[60:63], v[152:155]
v_add_u32 v12, s56, v10
v_mfma_f32_16x16x32_bf16 v[132:135], v[92:95], v[48:51], v[132:135]
v_add_u32 v112, s56, v116
v_mfma_f32_16x16x32_bf16 v[140:143], v[92:95], v[52:55], v[140:143]
v_add_u32 v113, s56, v117
v_mfma_f32_16x16x32_bf16 v[148:151], v[92:95], v[56:59], v[148:151]
v_add_u32 v114, s56, v118
v_mfma_f32_16x16x32_bf16 v[156:159], v[92:95], v[60:63], v[156:159]
v_add_u32 v115, s56, v119
v_mfma_f32_16x16x32_bf16 v[160:163], v[96:99], v[48:51], v[160:163]
ds_read_b64_tr_b16 v[64:65], v114 offset:8192
v_mfma_f32_16x16x32_bf16 v[168:171], v[96:99], v[52:55], v[168:171]
ds_read_b64_tr_b16 v[66:67], v114 offset:8704
v_mfma_f32_16x16x32_bf16 v[176:179], v[96:99], v[56:59], v[176:179]
ds_read_b64_tr_b16 v[68:69], v115 offset:8192
v_mfma_f32_16x16x32_bf16 v[184:187], v[96:99], v[60:63], v[184:187]
ds_read_b64_tr_b16 v[70:71], v115 offset:8704
v_mfma_f32_16x16x32_bf16 v[164:167], v[100:103], v[48:51], v[164:167]
ds_read_b64_tr_b16 v[72:73], v112 offset:16384
v_mfma_f32_16x16x32_bf16 v[172:175], v[100:103], v[52:55], v[172:175]
ds_read_b64_tr_b16 v[74:75], v112 offset:16896
v_mfma_f32_16x16x32_bf16 v[180:183], v[100:103], v[56:59], v[180:183]
ds_read_b64_tr_b16 v[76:77], v113 offset:16384
v_mfma_f32_16x16x32_bf16 v[188:191], v[100:103], v[60:63], v[188:191]
ds_read_b64_tr_b16 v[78:79], v113 offset:16896
v_mfma_f32_16x16x32_bf16 v[192:195], v[104:107], v[48:51], v[192:195]
ds_read_b64_tr_b16 v[80:81], v114 offset:16384
v_mfma_f32_16x16x32_bf16 v[200:203], v[104:107], v[52:55], v[200:203]
ds_read_b64_tr_b16 v[82:83], v114 offset:16896
v_mfma_f32_16x16x32_bf16 v[208:211], v[104:107], v[56:59], v[208:211]
ds_read_b64_tr_b16 v[84:85], v115 offset:16384
v_mfma_f32_16x16x32_bf16 v[216:219], v[104:107], v[60:63], v[216:219]
ds_read_b64_tr_b16 v[86:87], v115 offset:16896
v_mfma_f32_16x16x32_bf16 v[196:199], v[108:111], v[48:51], v[196:199]
ds_read_b128 v[32:35], v12 offset:0
v_mfma_f32_16x16x32_bf16 v[204:207], v[108:111], v[52:55], v[204:207]
ds_read_b128 v[36:39], v12 offset:2048
v_mfma_f32_16x16x32_bf16 v[212:215], v[108:111], v[56:59], v[212:215]
ds_read_b128 v[40:43], v12 offset:4096
v_mfma_f32_16x16x32_bf16 v[220:223], v[108:111], v[60:63], v[220:223]
ds_read_b128 v[44:47], v12 offset:6144
v_mfma_f32_16x16x32_bf16 v[232:235], v[88:91], v[244:247], v[232:235]
v_mfma_f32_16x16x32_bf16 v[236:239], v[92:95], v[244:247], v[236:239]
v_mfma_f32_16x16x32_bf16 v[240:243], v[96:99], v[244:247], v[240:243]
s_add_u32 s57, s57, 1
s_cmp_lt_u32 s57, 8
s_waitcnt lgkmcnt(0)
s_cbranch_scc1 L_cloopM1
s_waitcnt vmcnt(0)
s_nop 7
v_lshlrev_b32 v2, 4, v9
v_add_u32 v2, 133376, v2
s_mov_b32 exec_lo, 0x00010001
s_mov_b32 exec_hi, 0x00010001
ds_write_b128 v2, v[232:235] offset:384
ds_write_b128 v2, v[236:239] offset:448
ds_write_b128 v2, v[240:243] offset:512
s_mov_b64 exec, -1
s_branch L_mepi
L_mv2:
s_barrier
v_add_u32 v12, s56, v10
v_add_u32 v112, s56, v116
v_add_u32 v113, s56, v117
v_add_u32 v114, s56, v118
v_add_u32 v115, s56, v119
ds_read_b64_tr_b16 v[64:65], v112 offset:0
ds_read_b64_tr_b16 v[66:67], v112 offset:512
ds_read_b64_tr_b16 v[68:69], v113 offset:0
ds_read_b64_tr_b16 v[70:71], v113 offset:512
ds_read_b64_tr_b16 v[72:73], v114 offset:0
ds_read_b64_tr_b16 v[74:75], v114 offset:512
ds_read_b64_tr_b16 v[76:77], v115 offset:0
ds_read_b64_tr_b16 v[78:79], v115 offset:512
ds_read_b64_tr_b16 v[80:81], v112 offset:8192
ds_read_b64_tr_b16 v[82:83], v112 offset:8704
ds_read_b64_tr_b16 v[84:85], v113 offset:8192
ds_read_b64_tr_b16 v[86:87], v113 offset:8704
ds_read_b128 v[32:35], v12 offset:0
ds_read_b128 v[36:39], v12 offset:2048
ds_read_b128 v[40:43], v12 offset:4096
ds_read_b128 v[44:47], v12 offset:6144
s_waitcnt lgkmcnt(0)
L_cloopM2:
v_mfma_f32_16x16x32_bf16 v[128:131], v[64:67], v[32:35], v[128:131]
v_add_u32 v12, s56, v11
v_mfma_f32_16x16x32_bf16 v[136:139], v[64:67], v[36:39], v[136:139]
ds_read_b64_tr_b16 v[88:89], v112 offset:4096
v_mfma_f32_16x16x32_bf16 v[144:147], v[64:67], v[40:43], v[144:147]
ds_read_b64_tr_b16 v[90:91], v112 offset:4608
v_mfma_f32_16x16x32_bf16 v[152:155], v[64:67], v[44:47], v[152:155]
ds_read_b64_tr_b16 v[92:93], v113 offset:4096
v_mfma_f32_16x16x32_bf16 v[132:135], v[68:71], v[32:35], v[132:135]
ds_read_b64_tr_b16 v[94:95], v113 offset:4608
v_mfma_f32_16x16x32_bf16 v[140:143], v[68:71], v[36:39], v[140:143]
ds_read_b64_tr_b16 v[96:97], v114 offset:4096
v_mfma_f32_16x16x32_bf16 v[148:151], v[68:71], v[40:43], v[148:151]
ds_read_b64_tr_b16 v[98:99], v114 offset:4608
v_mfma_f32_16x16x32_bf16 v[156:159], v[68:71], v[44:47], v[156:159]
ds_read_b64_tr_b16 v[100:101], v115 offset:4096
v_mfma_f32_16x16x32_bf16 v[160:163], v[72:75], v[32:35], v[160:163]
ds_read_b64_tr_b16 v[102:103], v115 offset:4608
v_mfma_f32_16x16x32_bf16 v[168:171], v[72:75], v[36:39], v[168:171]
ds_read_b64_tr_b16 v[104:105], v112 offset:12288
v_mfma_f32_16x16x32_bf16 v[176:179], v[72:75], v[40:43], v[176:179]
ds_read_b64_tr_b16 v[106:107], v112 offset:12800
v_mfma_f32_16x16x32_bf16 v[184:187], v[72:75], v[44:47], v[184:187]
ds_read_b64_tr_b16 v[108:109], v113 offset:12288
v_mfma_f32_16x16x32_bf16 v[164:167], v[76:79], v[32:35], v[164:167]
ds_read_b64_tr_b16 v[110:111], v113 offset:12800
v_mfma_f32_16x16x32_bf16 v[172:175], v[76:79], v[36:39], v[172:175]
ds_read_b128 v[48:51], v12 offset:0
v_mfma_f32_16x16x32_bf16 v[180:183], v[76:79], v[40:43], v[180:183]
ds_read_b128 v[52:55], v12 offset:2048
v_mfma_f32_16x16x32_bf16 v[188:191], v[76:79], v[44:47], v[188:191]
ds_read_b128 v[56:59], v12 offset:4096
v_mfma_f32_16x16x32_bf16 v[192:195], v[80:83], v[32:35], v[192:195]
ds_read_b128 v[60:63], v12 offset:6144
v_mfma_f32_16x16x32_bf16 v[200:203], v[80:83], v[36:39], v[200:203]
v_mfma_f32_16x16x32_bf16 v[208:211], v[80:83], v[40:43], v[208:211]
v_mfma_f32_16x16x32_bf16 v[216:219], v[80:83], v[44:47], v[216:219]
v_mfma_f32_16x16x32_bf16 v[196:199], v[84:87], v[32:35], v[196:199]
v_mfma_f32_16x16x32_bf16 v[204:207], v[84:87], v[36:39], v[204:207]
v_mfma_f32_16x16x32_bf16 v[212:215], v[84:87], v[40:43], v[212:215]
v_mfma_f32_16x16x32_bf16 v[220:223], v[84:87], v[44:47], v[220:223]
v_mfma_f32_16x16x32_bf16 v[232:235], v[76:79], v[244:247], v[232:235]
v_mfma_f32_16x16x32_bf16 v[236:239], v[80:83], v[244:247], v[236:239]
v_mfma_f32_16x16x32_bf16 v[240:243], v[84:87], v[244:247], v[240:243]
s_waitcnt lgkmcnt(0)
s_barrier
v_mfma_f32_16x16x32_bf16 v[128:131], v[88:91], v[48:51], v[128:131]
s_add_u32 s56, s56, 43008
v_mfma_f32_16x16x32_bf16 v[136:139], v[88:91], v[52:55], v[136:139]
s_cmp_eq_u32 s56, 129024
v_mfma_f32_16x16x32_bf16 v[144:147], v[88:91], v[56:59], v[144:147]
s_cselect_b32 s56, 0, s56
v_mfma_f32_16x16x32_bf16 v[152:155], v[88:91], v[60:63], v[152:155]
v_add_u32 v12, s56, v10
v_mfma_f32_16x16x32_bf16 v[132:135], v[92:95], v[48:51], v[132:135]
v_add_u32 v112, s56, v116
v_mfma_f32_16x16x32_bf16 v[140:143], v[92:95], v[52:55], v[140:143]
v_add_u32 v113, s56, v117
v_mfma_f32_16x16x32_bf16 v[148:151], v[92:95], v[56:59], v[148:151]
v_add_u32 v114, s56, v118
v_mfma_f32_16x16x32_bf16 v[156:159], v[92:95], v[60:63], v[156:159]
v_add_u32 v115, s56, v119
v_mfma_f32_16x16x32_bf16 v[160:163], v[96:99], v[48:51], v[160:163]
ds_read_b64_tr_b16 v[64:65], v112 offset:0
v_mfma_f32_16x16x32_bf16 v[168:171], v[96:99], v[52:55], v[168:171]
ds_read_b64_tr_b16 v[66:67], v112 offset:512
v_mfma_f32_16x16x32_bf16 v[176:179], v[96:99], v[56:59], v[176:179]
ds_read_b64_tr_b16 v[68:69], v113 offset:0
v_mfma_f32_16x16x32_bf16 v[184:187], v[96:99], v[60:63], v[184:187]
ds_read_b64_tr_b16 v[70:71], v113 offset:512
v_mfma_f32_16x16x32_bf16 v[164:167], v[100:103], v[48:51], v[164:167]
ds_read_b64_tr_b16 v[72:73], v114 offset:0
v_mfma_f32_16x16x32_bf16 v[172:175], v[100:103], v[52:55], v[172:175]
ds_read_b64_tr_b16 v[74:75], v114 offset:512
v_mfma_f32_16x16x32_bf16 v[180:183], v[100:103], v[56:59], v[180:183]
ds_read_b64_tr_b16 v[76:77], v115 offset:0
v_mfma_f32_16x16x32_bf16 v[188:191], v[100:103], v[60:63], v[188:191]
ds_read_b64_tr_b16 v[78:79], v115 offset:512
v_mfma_f32_16x16x32_bf16 v[192:195], v[104:107], v[48:51], v[192:195]
ds_read_b64_tr_b16 v[80:81], v112 offset:8192
v_mfma_f32_16x16x32_bf16 v[200:203], v[104:107], v[52:55], v[200:203]
ds_read_b64_tr_b16 v[82:83], v112 offset:8704
v_mfma_f32_16x16x32_bf16 v[208:211], v[104:107], v[56:59], v[208:211]
ds_read_b64_tr_b16 v[84:85], v113 offset:8192
v_mfma_f32_16x16x32_bf16 v[216:219], v[104:107], v[60:63], v[216:219]
ds_read_b64_tr_b16 v[86:87], v113 offset:8704
v_mfma_f32_16x16x32_bf16 v[196:199], v[108:111], v[48:51], v[196:199]
ds_read_b128 v[32:35], v12 offset:0
v_mfma_f32_16x16x32_bf16 v[204:207], v[108:111], v[52:55], v[204:207]
ds_read_b128 v[36:39], v12 offset:2048
v_mfma_f32_16x16x32_bf16 v[212:215], v[108:111], v[56:59], v[212:215]
ds_read_b128 v[40:43], v12 offset:4096
v_mfma_f32_16x16x32_bf16 v[220:223], v[108:111], v[60:63], v[220:223]
ds_read_b128 v[44:47], v12 offset:6144
v_mfma_f32_16x16x32_bf16 v[232:235], v[100:103], v[244:247], v[232:235]
v_mfma_f32_16x16x32_bf16 v[236:239], v[104:107], v[244:247], v[236:239]
v_mfma_f32_16x16x32_bf16 v[240:243], v[108:111], v[244:247], v[240:243]
s_add_u32 s57, s57, 1
s_cmp_lt_u32 s57, 8
s_waitcnt lgkmcnt(0)
s_cbranch_scc1 L_cloopM2
s_waitcnt vmcnt(0)
s_nop 7
v_lshlrev_b32 v2, 4, v9
v_add_u32 v2, 133376, v2
s_mov_b32 exec_lo, 0x00010001
s_mov_b32 exec_hi, 0x00010001
ds_write_b128 v2, v[232:235] offset:192
ds_write_b128 v2, v[236:239] offset:256
ds_write_b128 v2, v[240:243] offset:320
s_mov_b64 exec, -1
s_branch L_mepi
L_mv3:
s_barrier
v_add_u32 v12, s56, v10
v_add_u32 v112, s56, v116
v_add_u32 v113, s56, v117
v_add_u32 v114, s56, v118
v_add_u32 v115, s56, v119
ds_read_b64_tr_b16 v[64:65], v114 offset:8192
ds_read_b64_tr_b16 v[66:67], v114 offset:8704
ds_read_b64_tr_b16 v[68:69], v115 offset:8192
ds_read_b64_tr_b16 v[70:71], v115 offset:8704
ds_read_b64_tr_b16 v[72:73], v112 offset:16384
ds_read_b64_tr_b16 v[74:75], v112 offset:16896
ds_read_b64_tr_b16 v[76:77], v113 offset:16384
ds_read_b64_tr_b16 v[78:79], v113 offset:16896
ds_read_b64_tr_b16 v[80:81], v114 offset:16384
ds_read_b64_tr_b16 v[82:83], v114 offset:16896
ds_read_b64_tr_b16 v[84:85], v115 offset:16384
ds_read_b64_tr_b16 v[86:87], v115 offset:16896
ds_read_b128 v[32:35], v12 offset:0
ds_read_b128 v[36:39], v12 offset:2048
ds_read_b128 v[40:43], v12 offset:4096
ds_read_b128 v[44:47], v12 offset:6144
s_waitcnt lgkmcnt(0)
L_cloopM3:
v_mfma_f32_16x16x32_bf16 v[128:131], v[64:67], v[32:35], v[128:131]
v_add_u32 v12, s56, v11
v_mfma_f32_16x16x32_bf16 v[136:139], v[64:67], v[36:39], v[136:139]
ds_read_b64_tr_b16 v[88:89], v114 offset:12288
v_mfma_f32_16x16x32_bf16 v[144:147], v[64:67], v[40:43], v[144:147]
ds_read_b64_tr_b16 v[90:91], v114 offset:12800
v_mfma_f32_16x16x32_bf16 v[152:155], v[64:67], v[44:47], v[152:155]
ds_read_b64_tr_b16 v[92:93], v115 offset:12288
v_mfma_f32_16x16x32_bf16 v[132:135], v[68:71], v[32:35], v[132:135]
ds_read_b64_tr_b16 v[94:95], v115 offset:12800
v_mfma_f32_16x16x32_bf16 v[140:143], v[68:71], v[36:39], v[140:143]
ds_read_b64_tr_b16 v[96:97], v112 offset:20480
v_mfma_f32_16x16x32_bf16 v[148:151], v[68:71], v[40:43], v[148:151]
ds_read_b64_tr_b16 v[98:99], v112 offset:20992
v_mfma_f32_16x16x32_bf16 v[156:159], v[68:71], v[44:47], v[156:159]
ds_read_b64_tr_b16 v[100:101], v113 offset:20480
v_mfma_f32_16x16x32_bf16 v[160:163], v[72:75], v[32:35], v[160:163]
ds_read_b64_tr_b16 v[102:103], v113 offset:20992
v_mfma_f32_16x16x32_bf16 v[168:171], v[72:75], v[36:39], v[168:171]
ds_read_b64_tr_b16 v[104:105], v114 offset:20480
v_mfma_f32_16x16x32_bf16 v[176:179], v[72:75], v[40:43], v[176:179]
ds_read_b64_tr_b16 v[106:107], v114 offset:20992
v_mfma_f32_16x16x32_bf16 v[184:187], v[72:75], v[44:47], v[184:187]
ds_read_b64_tr_b16 v[108:109], v115 offset:20480
v_mfma_f32_16x16x32_bf16 v[164:167], v[76:79], v[32:35], v[164:167]
ds_read_b64_tr_b16 v[110:111], v115 offset:20992
v_mfma_f32_16x16x32_bf16 v[172:175], v[76:79], v[36:39], v[172:175]
ds_read_b128 v[48:51], v12 offset:0
v_mfma_f32_16x16x32_bf16 v[180:183], v[76:79], v[40:43], v[180:183]
ds_read_b128 v[52:55], v12 offset:2048
v_mfma_f32_16x16x32_bf16 v[188:191], v[76:79], v[44:47], v[188:191]
ds_read_b128 v[56:59], v12 offset:4096
v_mfma_f32_16x16x32_bf16 v[192:195], v[80:83], v[32:35], v[192:195]
ds_read_b128 v[60:63], v12 offset:6144
v_mfma_f32_16x16x32_bf16 v[200:203], v[80:83], v[36:39], v[200:203]
v_mfma_f32_16x16x32_bf16 v[208:211], v[80:83], v[40:43], v[208:211]
v_mfma_f32_16x16x32_bf16 v[216:219], v[80:83], v[44:47], v[216:219]
v_mfma_f32_16x16x32_bf16 v[196:199], v[84:87], v[32:35], v[196:199]
v_mfma_f32_16x16x32_bf16 v[204:207], v[84:87], v[36:39], v[204:207]
v_mfma_f32_16x16x32_bf16 v[212:215], v[84:87], v[40:43], v[212:215]
v_mfma_f32_16x16x32_bf16 v[220:223], v[84:87], v[44:47], v[220:223]
v_mfma_f32_16x16x32_bf16 v[232:235], v[76:79], v[244:247], v[232:235]
v_mfma_f32_16x16x32_bf16 v[236:239], v[80:83], v[244:247], v[236:239]
v_mfma_f32_16x16x32_bf16 v[240:243], v[84:87], v[244:247], v[240:243]
s_waitcnt lgkmcnt(0)
s_barrier
v_mfma_f32_16x16x32_bf16 v[128:131], v[88:91], v[48:51], v[128:131]
s_add_u32 s56, s56, 43008
v_mfma_f32_16x16x32_bf16 v[136:139], v[88:91], v[52:55], v[136:139]
s_cmp_eq_u32 s56, 129024
v_mfma_f32_16x16x32_bf16 v[144:147], v[88:91], v[56:59], v[144:147]
s_cselect_b32 s56, 0, s56
v_mfma_f32_16x16x32_bf16 v[152:155], v[88:91], v[60:63], v[152:155]
v_add_u32 v12, s56, v10
v_mfma_f32_16x16x32_bf16 v[132:135], v[92:95], v[48:51], v[132:135]
v_add_u32 v112, s56, v116
v_mfma_f32_16x16x32_bf16 v[140:143], v[92:95], v[52:55], v[140:143]
v_add_u32 v113, s56, v117
v_mfma_f32_16x16x32_bf16 v[148:151], v[92:95], v[56:59], v[148:151]
v_add_u32 v114, s56, v118
v_mfma_f32_16x16x32_bf16 v[156:159], v[92:95], v[60:63], v[156:159]
v_add_u32 v115, s56, v119
v_mfma_f32_16x16x32_bf16 v[160:163], v[96:99], v[48:51], v[160:163]
ds_read_b64_tr_b16 v[64:65], v114 offset:8192
v_mfma_f32_16x16x32_bf16 v[168:171], v[96:99], v[52:55], v[168:171]
ds_read_b64_tr_b16 v[66:67], v114 offset:8704
v_mfma_f32_16x16x32_bf16 v[176:179], v[96:99], v[56:59], v[176:179]
ds_read_b64_tr_b16 v[68:69], v115 offset:8192
v_mfma_f32_16x16x32_bf16 v[184:187], v[96:99], v[60:63], v[184:187]
ds_read_b64_tr_b16 v[70:71], v115 offset:8704
v_mfma_f32_16x16x32_bf16 v[164:167], v[100:103], v[48:51], v[164:167]
ds_read_b64_tr_b16 v[72:73], v112 offset:16384
v_mfma_f32_16x16x32_bf16 v[172:175], v[100:103], v[52:55], v[172:175]
ds_read_b64_tr_b16 v[74:75], v112 offset:16896
v_mfma_f32_16x16x32_bf16 v[180:183], v[100:103], v[56:59], v[180:183]
ds_read_b64_tr_b16 v[76:77], v113 offset:16384
v_mfma_f32_16x16x32_bf16 v[188:191], v[100:103], v[60:63], v[188:191]
ds_read_b64_tr_b16 v[78:79], v113 offset:16896
v_mfma_f32_16x16x32_bf16 v[192:195], v[104:107], v[48:51], v[192:195]
ds_read_b64_tr_b16 v[80:81], v114 offset:16384
v_mfma_f32_16x16x32_bf16 v[200:203], v[104:107], v[52:55], v[200:203]
ds_read_b64_tr_b16 v[82:83], v114 offset:16896
v_mfma_f32_16x16x32_bf16 v[208:211], v[104:107], v[56:59], v[208:211]
ds_read_b64_tr_b16 v[84:85], v115 offset:16384
v_mfma_f32_16x16x32_bf16 v[216:219], v[104:107], v[60:63], v[216:219]
ds_read_b64_tr_b16 v[86:87], v115 offset:16896
v_mfma_f32_16x16x32_bf16 v[196:199], v[108:111], v[48:51], v[196:199]
ds_read_b128 v[32:35], v12 offset:0
v_mfma_f32_16x16x32_bf16 v[204:207], v[108:111], v[52:55], v[204:207]
ds_read_b128 v[36:39], v12 offset:2048
v_mfma_f32_16x16x32_bf16 v[212:215], v[108:111], v[56:59], v[212:215]
ds_read_b128 v[40:43], v12 offset:4096
v_mfma_f32_16x16x32_bf16 v[220:223], v[108:111], v[60:63], v[220:223]
ds_read_b128 v[44:47], v12 offset:6144
v_mfma_f32_16x16x32_bf16 v[232:235], v[100:103], v[244:247], v[232:235]
v_mfma_f32_16x16x32_bf16 v[236:239], v[104:107], v[244:247], v[236:239]
v_mfma_f32_16x16x32_bf16 v[240:243], v[108:111], v[244:247], v[240:243]
s_add_u32 s57, s57, 1
s_cmp_lt_u32 s57, 8
s_waitcnt lgkmcnt(0)
s_cbranch_scc1 L_cloopM3
s_waitcnt vmcnt(0)
s_nop 7
v_lshlrev_b32 v2, 4, v9
v_add_u32 v2, 133376, v2
s_mov_b32 exec_lo, 0x00010001
s_mov_b32 exec_hi, 0x00010001
ds_write_b128 v2, v[232:235] offset:576
ds_write_b128 v2, v[236:239] offset:640
ds_write_b128 v2, v[240:243] offset:704
s_mov_b64 exec, -1
L_mepi:
s_waitcnt lgkmcnt(0)
s_barrier
s_lshr_b32 s52, s26, 1
s_lshl_b32 s52, s52, 8
v_lshl_add_u32 v2, v8, 2, s52
v_add_u32 v2, 131136, v2
ds_read_b32 v80, v2 offset:1152
ds_read_b32 v84, v2 offset:1728
ds_read_b32 v81, v2 offset:1216
ds_read_b32 v85, v2 offset:1792
ds_read_b32 v82, v2 offset:1280
ds_read_b32 v86, v2 offset:1856
ds_read_b32 v83, v2 offset:1344
ds_read_b32 v87, v2 offset:1920
s_and_b32 s53, s26, 1
s_mul_i32 s54, s53, 384
v_lshl_add_u32 v3, v9, 4, s54
v_add_u32 v3, 133376, v3
ds_read_b128 v[32:35], v3 offset:0
ds_read_b128 v[36:39], v3 offset:64
ds_read_b128 v[40:43], v3 offset:128
ds_read_b128 v[44:47], v3 offset:192
ds_read_b128 v[48:51], v3 offset:256
ds_read_b128 v[52:55], v3 offset:320
v_lshlrev_b32 v56, 16, v16
v_and_b32 v57, s35, v16
v_lshlrev_b32 v58, 16, v17
v_and_b32 v59, s35, v17
v_lshlrev_b32 v60, 16, v18
v_and_b32 v61, s35, v18
v_lshlrev_b32 v62, 16, v19
v_and_b32 v63, s35, v19
v_lshlrev_b32 v64, 16, v20
v_and_b32 v65, s35, v20
v_lshlrev_b32 v66, 16, v21
v_and_b32 v67, s35, v21
v_lshlrev_b32 v68, 16, v22
v_and_b32 v69, s35, v22
v_lshlrev_b32 v70, 16, v23
v_and_b32 v71, s35, v23
v_lshlrev_b32 v72, 16, v24
v_and_b32 v73, s35, v24
v_lshlrev_b32 v74, 16, v25
v_and_b32 v75, s35, v25
v_lshlrev_b32 v76, 16, v26
v_and_b32 v77, s35, v26
v_lshlrev_b32 v78, 16, v27
v_and_b32 v79, s35, v27
s_mov_b32 s60, 0xbdd2d3e8
s_mov_b32 s61, 0xbdd2d3e8
v_mov_b32 v112, 0xc0135761
v_mov_b32 v113, 0xc0135761
v_lshlrev_b32 v15, 4, v0
s_lshr_b32 s52, s26, 1
s_lshl_b32 s52, s52, 2
s_lshl_b32 s54, s27, 3
s_add_u32 s52, s52, s54
s_mul_i32 s52, s52, 60
s_mul_i32 s54, s53, 3
s_add_u32 s52, s52, s54
s_add_u32 s52, s52, s29
s_add_u32 s52, s52, 16
s_lshl_b32 s52, s52, 10
s_sub_u32 s55, s30, s54
s_waitcnt lgkmcnt(0)
v_pk_fma_f32 v[88:89], v[32:33], v[84:85], v[56:57] op_sel:[0,0,0] op_sel_hi:[1,0,1] neg_lo:[0,1,0] neg_hi:[0,1,0]
v_pk_fma_f32 v[90:91], v[34:35], v[84:85], v[58:59] op_sel:[0,0,0] op_sel_hi:[1,0,1] neg_lo:[0,1,0] neg_hi:[0,1,0]
v_pk_fma_f32 v[92:93], v[36:37], v[84:85], v[60:61] op_sel:[0,0,0] op_sel_hi:[1,0,1] neg_lo:[0,1,0] neg_hi:[0,1,0]
v_pk_fma_f32 v[94:95], v[38:39], v[84:85], v[62:63] op_sel:[0,0,0] op_sel_hi:[1,0,1] neg_lo:[0,1,0] neg_hi:[0,1,0]
v_pk_fma_f32 v[88:89], v[128:129], v[80:81], v[88:89] op_sel:[0,0,0] op_sel_hi:[1,0,1]
v_pk_fma_f32 v[90:91], v[130:131], v[80:81], v[90:91] op_sel:[0,0,0] op_sel_hi:[1,0,1]
v_pk_fma_f32 v[92:93], v[132:133], v[80:81], v[92:93] op_sel:[0,0,0] op_sel_hi:[1,0,1]
v_pk_fma_f32 v[94:95], v[134:135], v[80:81], v[94:95] op_sel:[0,0,0] op_sel_hi:[1,0,1]
v_pk_mul_f32 v[96:97], v[88:89], v[88:89]
v_pk_mul_f32 v[98:99], v[90:91], v[90:91]
v_pk_mul_f32 v[100:101], v[92:93], v[92:93]
v_pk_mul_f32 v[102:103], v[94:95], v[94:95]
v_pk_fma_f32 v[96:97], v[96:97], s[60:61], v[112:113]
v_pk_fma_f32 v[98:99], v[98:99], s[60:61], v[112:113]
v_pk_fma_f32 v[100:101], v[100:101], s[60:61], v[112:113]
v_pk_fma_f32 v[102:103], v[102:103], s[60:61], v[112:113]
v_pk_mul_f32 v[96:97], v[96:97], v[88:89]
v_pk_mul_f32 v[98:99], v[98:99], v[90:91]
v_pk_mul_f32 v[100:101], v[100:101], v[92:93]
v_pk_mul_f32 v[102:103], v[102:103], v[94:95]
v_exp_f32 v96, v96
v_exp_f32 v97, v97
v_exp_f32 v98, v98
v_exp_f32 v99, v99
v_exp_f32 v100, v100
v_exp_f32 v101, v101
v_exp_f32 v102, v102
v_exp_f32 v103, v103
v_pk_add_f32 v[96:97], v[96:97], 1.0 op_sel_hi:[1,0]
v_pk_add_f32 v[98:99], v[98:99], 1.0 op_sel_hi:[1,0]
v_pk_add_f32 v[100:101], v[100:101], 1.0 op_sel_hi:[1,0]
v_pk_add_f32 v[102:103], v[102:103], 1.0 op_sel_hi:[1,0]
v_rcp_f32 v96, v96
v_rcp_f32 v97, v97
v_rcp_f32 v98, v98
v_rcp_f32 v99, v99
v_rcp_f32 v100, v100
v_rcp_f32 v101, v101
v_rcp_f32 v102, v102
v_rcp_f32 v103, v103
v_pk_mul_f32 v[96:97], v[96:97], v[88:89]
v_pk_mul_f32 v[98:99], v[98:99], v[90:91]
v_pk_mul_f32 v[100:101], v[100:101], v[92:93]
v_pk_mul_f32 v[102:103], v[102:103], v[94:95]
v_cvt_pk_bf16_f32 v104, v96, v97
v_cvt_pk_bf16_f32 v105, v98, v99
v_cvt_pk_bf16_f32 v106, v100, v101
v_cvt_pk_bf16_f32 v107, v102, v103
s_add_u32 s53, s52, 0
buffer_store_dwordx4 v[104:107], v15, s[36:39], s53 offen sc1
v_pk_fma_f32 v[88:89], v[32:33], v[84:85], v[56:57] op_sel:[0,1,0] op_sel_hi:[1,1,1] neg_lo:[0,1,0] neg_hi:[0,1,0]
v_pk_fma_f32 v[90:91], v[34:35], v[84:85], v[58:59] op_sel:[0,1,0] op_sel_hi:[1,1,1] neg_lo:[0,1,0] neg_hi:[0,1,0]
v_pk_fma_f32 v[92:93], v[36:37], v[84:85], v[60:61] op_sel:[0,1,0] op_sel_hi:[1,1,1] neg_lo:[0,1,0] neg_hi:[0,1,0]
v_pk_fma_f32 v[94:95], v[38:39], v[84:85], v[62:63] op_sel:[0,1,0] op_sel_hi:[1,1,1] neg_lo:[0,1,0] neg_hi:[0,1,0]
v_pk_fma_f32 v[88:89], v[136:137], v[80:81], v[88:89] op_sel:[0,1,0] op_sel_hi:[1,1,1]
v_pk_fma_f32 v[90:91], v[138:139], v[80:81], v[90:91] op_sel:[0,1,0] op_sel_hi:[1,1,1]
v_pk_fma_f32 v[92:93], v[140:141], v[80:81], v[92:93] op_sel:[0,1,0] op_sel_hi:[1,1,1]
v_pk_fma_f32 v[94:95], v[142:143], v[80:81], v[94:95] op_sel:[0,1,0] op_sel_hi:[1,1,1]
v_pk_mul_f32 v[96:97], v[88:89], v[88:89]
v_pk_mul_f32 v[98:99], v[90:91], v[90:91]
v_pk_mul_f32 v[100:101], v[92:93], v[92:93]
v_pk_mul_f32 v[102:103], v[94:95], v[94:95]
v_pk_fma_f32 v[96:97], v[96:97], s[60:61], v[112:113]
v_pk_fma_f32 v[98:99], v[98:99], s[60:61], v[112:113]
v_pk_fma_f32 v[100:101], v[100:101], s[60:61], v[112:113]
v_pk_fma_f32 v[102:103], v[102:103], s[60:61], v[112:113]
v_pk_mul_f32 v[96:97], v[96:97], v[88:89]
v_pk_mul_f32 v[98:99], v[98:99], v[90:91]
v_pk_mul_f32 v[100:101], v[100:101], v[92:93]
v_pk_mul_f32 v[102:103], v[102:103], v[94:95]
v_exp_f32 v96, v96
v_exp_f32 v97, v97
v_exp_f32 v98, v98
v_exp_f32 v99, v99
v_exp_f32 v100, v100
v_exp_f32 v101, v101
v_exp_f32 v102, v102
v_exp_f32 v103, v103
v_pk_add_f32 v[96:97], v[96:97], 1.0 op_sel_hi:[1,0]
v_pk_add_f32 v[98:99], v[98:99], 1.0 op_sel_hi:[1,0]
v_pk_add_f32 v[100:101], v[100:101], 1.0 op_sel_hi:[1,0]
v_pk_add_f32 v[102:103], v[102:103], 1.0 op_sel_hi:[1,0]
v_rcp_f32 v96, v96
v_rcp_f32 v97, v97
v_rcp_f32 v98, v98
v_rcp_f32 v99, v99
v_rcp_f32 v100, v100
v_rcp_f32 v101, v101
v_rcp_f32 v102, v102
v_rcp_f32 v103, v103
v_pk_mul_f32 v[96:97], v[96:97], v[88:89]
v_pk_mul_f32 v[98:99], v[98:99], v[90:91]
v_pk_mul_f32 v[100:101], v[100:101], v[92:93]
v_pk_mul_f32 v[102:103], v[102:103], v[94:95]
v_cvt_pk_bf16_f32 v108, v96, v97
v_cvt_pk_bf16_f32 v109, v98, v99
v_cvt_pk_bf16_f32 v110, v100, v101
v_cvt_pk_bf16_f32 v111, v102, v103
s_add_u32 s53, s52, 61440
buffer_store_dwordx4 v[108:111], v15, s[36:39], s53 offen sc1
v_pk_fma_f32 v[88:89], v[32:33], v[86:87], v[56:57] op_sel:[0,0,0] op_sel_hi:[1,0,1] neg_lo:[0,1,0] neg_hi:[0,1,0]
v_pk_fma_f32 v[90:91], v[34:35], v[86:87], v[58:59] op_sel:[0,0,0] op_sel_hi:[1,0,1] neg_lo:[0,1,0] neg_hi:[0,1,0]
v_pk_fma_f32 v[92:93], v[36:37], v[86:87], v[60:61] op_sel:[0,0,0] op_sel_hi:[1,0,1] neg_lo:[0,1,0] neg_hi:[0,1,0]
v_pk_fma_f32 v[94:95], v[38:39], v[86:87], v[62:63] op_sel:[0,0,0] op_sel_hi:[1,0,1] neg_lo:[0,1,0] neg_hi:[0,1,0]
v_pk_fma_f32 v[88:89], v[144:145], v[82:83], v[88:89] op_sel:[0,0,0] op_sel_hi:[1,0,1]
v_pk_fma_f32 v[90:91], v[146:147], v[82:83], v[90:91] op_sel:[0,0,0] op_sel_hi:[1,0,1]
v_pk_fma_f32 v[92:93], v[148:149], v[82:83], v[92:93] op_sel:[0,0,0] op_sel_hi:[1,0,1]
v_pk_fma_f32 v[94:95], v[150:151], v[82:83], v[94:95] op_sel:[0,0,0] op_sel_hi:[1,0,1]
v_pk_mul_f32 v[96:97], v[88:89], v[88:89]
v_pk_mul_f32 v[98:99], v[90:91], v[90:91]
v_pk_mul_f32 v[100:101], v[92:93], v[92:93]
v_pk_mul_f32 v[102:103], v[94:95], v[94:95]
v_pk_fma_f32 v[96:97], v[96:97], s[60:61], v[112:113]
v_pk_fma_f32 v[98:99], v[98:99], s[60:61], v[112:113]
v_pk_fma_f32 v[100:101], v[100:101], s[60:61], v[112:113]
v_pk_fma_f32 v[102:103], v[102:103], s[60:61], v[112:113]
v_pk_mul_f32 v[96:97], v[96:97], v[88:89]
v_pk_mul_f32 v[98:99], v[98:99], v[90:91]
v_pk_mul_f32 v[100:101], v[100:101], v[92:93]
v_pk_mul_f32 v[102:103], v[102:103], v[94:95]
v_exp_f32 v96, v96
v_exp_f32 v97, v97
v_exp_f32 v98, v98
v_exp_f32 v99, v99
v_exp_f32 v100, v100
v_exp_f32 v101, v101
v_exp_f32 v102, v102
v_exp_f32 v103, v103
v_pk_add_f32 v[96:97], v[96:97], 1.0 op_sel_hi:[1,0]
v_pk_add_f32 v[98:99], v[98:99], 1.0 op_sel_hi:[1,0]
v_pk_add_f32 v[100:101], v[100:101], 1.0 op_sel_hi:[1,0]
v_pk_add_f32 v[102:103], v[102:103], 1.0 op_sel_hi:[1,0]
v_rcp_f32 v96, v96
v_rcp_f32 v97, v97
v_rcp_f32 v98, v98
v_rcp_f32 v99, v99
v_rcp_f32 v100, v100
v_rcp_f32 v101, v101
v_rcp_f32 v102, v102
v_rcp_f32 v103, v103
v_pk_mul_f32 v[96:97], v[96:97], v[88:89]
v_pk_mul_f32 v[98:99], v[98:99], v[90:91]
v_pk_mul_f32 v[100:101], v[100:101], v[92:93]
v_pk_mul_f32 v[102:103], v[102:103], v[94:95]
v_cvt_pk_bf16_f32 v104, v96, v97
v_cvt_pk_bf16_f32 v105, v98, v99
v_cvt_pk_bf16_f32 v106, v100, v101
v_cvt_pk_bf16_f32 v107, v102, v103
s_add_u32 s53, s52, 122880
buffer_store_dwordx4 v[104:107], v15, s[36:39], s53 offen sc1
v_pk_fma_f32 v[88:89], v[32:33], v[86:87], v[56:57] op_sel:[0,1,0] op_sel_hi:[1,1,1] neg_lo:[0,1,0] neg_hi:[0,1,0]
v_pk_fma_f32 v[90:91], v[34:35], v[86:87], v[58:59] op_sel:[0,1,0] op_sel_hi:[1,1,1] neg_lo:[0,1,0] neg_hi:[0,1,0]
v_pk_fma_f32 v[92:93], v[36:37], v[86:87], v[60:61] op_sel:[0,1,0] op_sel_hi:[1,1,1] neg_lo:[0,1,0] neg_hi:[0,1,0]
v_pk_fma_f32 v[94:95], v[38:39], v[86:87], v[62:63] op_sel:[0,1,0] op_sel_hi:[1,1,1] neg_lo:[0,1,0] neg_hi:[0,1,0]
v_pk_fma_f32 v[88:89], v[152:153], v[82:83], v[88:89] op_sel:[0,1,0] op_sel_hi:[1,1,1]
v_pk_fma_f32 v[90:91], v[154:155], v[82:83], v[90:91] op_sel:[0,1,0] op_sel_hi:[1,1,1]
v_pk_fma_f32 v[92:93], v[156:157], v[82:83], v[92:93] op_sel:[0,1,0] op_sel_hi:[1,1,1]
v_pk_fma_f32 v[94:95], v[158:159], v[82:83], v[94:95] op_sel:[0,1,0] op_sel_hi:[1,1,1]
v_pk_mul_f32 v[96:97], v[88:89], v[88:89]
v_pk_mul_f32 v[98:99], v[90:91], v[90:91]
v_pk_mul_f32 v[100:101], v[92:93], v[92:93]
v_pk_mul_f32 v[102:103], v[94:95], v[94:95]
v_pk_fma_f32 v[96:97], v[96:97], s[60:61], v[112:113]
v_pk_fma_f32 v[98:99], v[98:99], s[60:61], v[112:113]
v_pk_fma_f32 v[100:101], v[100:101], s[60:61], v[112:113]
v_pk_fma_f32 v[102:103], v[102:103], s[60:61], v[112:113]
v_pk_mul_f32 v[96:97], v[96:97], v[88:89]
v_pk_mul_f32 v[98:99], v[98:99], v[90:91]
v_pk_mul_f32 v[100:101], v[100:101], v[92:93]
v_pk_mul_f32 v[102:103], v[102:103], v[94:95]
v_exp_f32 v96, v96
v_exp_f32 v97, v97
v_exp_f32 v98, v98
v_exp_f32 v99, v99
v_exp_f32 v100, v100
v_exp_f32 v101, v101
v_exp_f32 v102, v102
v_exp_f32 v103, v103
v_pk_add_f32 v[96:97], v[96:97], 1.0 op_sel_hi:[1,0]
v_pk_add_f32 v[98:99], v[98:99], 1.0 op_sel_hi:[1,0]
v_pk_add_f32 v[100:101], v[100:101], 1.0 op_sel_hi:[1,0]
v_pk_add_f32 v[102:103], v[102:103], 1.0 op_sel_hi:[1,0]
v_rcp_f32 v96, v96
v_rcp_f32 v97, v97
v_rcp_f32 v98, v98
v_rcp_f32 v99, v99
v_rcp_f32 v100, v100
v_rcp_f32 v101, v101
v_rcp_f32 v102, v102
v_rcp_f32 v103, v103
v_pk_mul_f32 v[96:97], v[96:97], v[88:89]
v_pk_mul_f32 v[98:99], v[98:99], v[90:91]
v_pk_mul_f32 v[100:101], v[100:101], v[92:93]
v_pk_mul_f32 v[102:103], v[102:103], v[94:95]
v_cvt_pk_bf16_f32 v108, v96, v97
v_cvt_pk_bf16_f32 v109, v98, v99
v_cvt_pk_bf16_f32 v110, v100, v101
v_cvt_pk_bf16_f32 v111, v102, v103
s_add_u32 s53, s52, 184320
buffer_store_dwordx4 v[108:111], v15, s[36:39], s53 offen sc1
v_pk_fma_f32 v[88:89], v[40:41], v[84:85], v[64:65] op_sel:[0,0,0] op_sel_hi:[1,0,1] neg_lo:[0,1,0] neg_hi:[0,1,0]
v_pk_fma_f32 v[90:91], v[42:43], v[84:85], v[66:67] op_sel:[0,0,0] op_sel_hi:[1,0,1] neg_lo:[0,1,0] neg_hi:[0,1,0]
v_pk_fma_f32 v[92:93], v[44:45], v[84:85], v[68:69] op_sel:[0,0,0] op_sel_hi:[1,0,1] neg_lo:[0,1,0] neg_hi:[0,1,0]
v_pk_fma_f32 v[94:95], v[46:47], v[84:85], v[70:71] op_sel:[0,0,0] op_sel_hi:[1,0,1] neg_lo:[0,1,0] neg_hi:[0,1,0]
v_pk_fma_f32 v[88:89], v[160:161], v[80:81], v[88:89] op_sel:[0,0,0] op_sel_hi:[1,0,1]
v_pk_fma_f32 v[90:91], v[162:163], v[80:81], v[90:91] op_sel:[0,0,0] op_sel_hi:[1,0,1]
v_pk_fma_f32 v[92:93], v[164:165], v[80:81], v[92:93] op_sel:[0,0,0] op_sel_hi:[1,0,1]
v_pk_fma_f32 v[94:95], v[166:167], v[80:81], v[94:95] op_sel:[0,0,0] op_sel_hi:[1,0,1]
v_pk_mul_f32 v[96:97], v[88:89], v[88:89]
v_pk_mul_f32 v[98:99], v[90:91], v[90:91]
v_pk_mul_f32 v[100:101], v[92:93], v[92:93]
v_pk_mul_f32 v[102:103], v[94:95], v[94:95]
v_pk_fma_f32 v[96:97], v[96:97], s[60:61], v[112:113]
v_pk_fma_f32 v[98:99], v[98:99], s[60:61], v[112:113]
v_pk_fma_f32 v[100:101], v[100:101], s[60:61], v[112:113]
v_pk_fma_f32 v[102:103], v[102:103], s[60:61], v[112:113]
v_pk_mul_f32 v[96:97], v[96:97], v[88:89]
v_pk_mul_f32 v[98:99], v[98:99], v[90:91]
v_pk_mul_f32 v[100:101], v[100:101], v[92:93]
v_pk_mul_f32 v[102:103], v[102:103], v[94:95]
v_exp_f32 v96, v96
v_exp_f32 v97, v97
v_exp_f32 v98, v98
v_exp_f32 v99, v99
v_exp_f32 v100, v100
v_exp_f32 v101, v101
v_exp_f32 v102, v102
v_exp_f32 v103, v103
v_pk_add_f32 v[96:97], v[96:97], 1.0 op_sel_hi:[1,0]
v_pk_add_f32 v[98:99], v[98:99], 1.0 op_sel_hi:[1,0]
v_pk_add_f32 v[100:101], v[100:101], 1.0 op_sel_hi:[1,0]
v_pk_add_f32 v[102:103], v[102:103], 1.0 op_sel_hi:[1,0]
v_rcp_f32 v96, v96
v_rcp_f32 v97, v97
v_rcp_f32 v98, v98
v_rcp_f32 v99, v99
v_rcp_f32 v100, v100
v_rcp_f32 v101, v101
v_rcp_f32 v102, v102
v_rcp_f32 v103, v103
v_pk_mul_f32 v[96:97], v[96:97], v[88:89]
v_pk_mul_f32 v[98:99], v[98:99], v[90:91]
v_pk_mul_f32 v[100:101], v[100:101], v[92:93]
v_pk_mul_f32 v[102:103], v[102:103], v[94:95]
v_cvt_pk_bf16_f32 v104, v96, v97
v_cvt_pk_bf16_f32 v105, v98, v99
v_cvt_pk_bf16_f32 v106, v100, v101
v_cvt_pk_bf16_f32 v107, v102, v103
s_add_u32 s53, s52, 1024
buffer_store_dwordx4 v[104:107], v15, s[36:39], s53 offen sc1
v_pk_fma_f32 v[88:89], v[40:41], v[84:85], v[64:65] op_sel:[0,1,0] op_sel_hi:[1,1,1] neg_lo:[0,1,0] neg_hi:[0,1,0]
v_pk_fma_f32 v[90:91], v[42:43], v[84:85], v[66:67] op_sel:[0,1,0] op_sel_hi:[1,1,1] neg_lo:[0,1,0] neg_hi:[0,1,0]
v_pk_fma_f32 v[92:93], v[44:45], v[84:85], v[68:69] op_sel:[0,1,0] op_sel_hi:[1,1,1] neg_lo:[0,1,0] neg_hi:[0,1,0]
v_pk_fma_f32 v[94:95], v[46:47], v[84:85], v[70:71] op_sel:[0,1,0] op_sel_hi:[1,1,1] neg_lo:[0,1,0] neg_hi:[0,1,0]
v_pk_fma_f32 v[88:89], v[168:169], v[80:81], v[88:89] op_sel:[0,1,0] op_sel_hi:[1,1,1]
v_pk_fma_f32 v[90:91], v[170:171], v[80:81], v[90:91] op_sel:[0,1,0] op_sel_hi:[1,1,1]
v_pk_fma_f32 v[92:93], v[172:173], v[80:81], v[92:93] op_sel:[0,1,0] op_sel_hi:[1,1,1]
v_pk_fma_f32 v[94:95], v[174:175], v[80:81], v[94:95] op_sel:[0,1,0] op_sel_hi:[1,1,1]
v_pk_mul_f32 v[96:97], v[88:89], v[88:89]
v_pk_mul_f32 v[98:99], v[90:91], v[90:91]
v_pk_mul_f32 v[100:101], v[92:93], v[92:93]
v_pk_mul_f32 v[102:103], v[94:95], v[94:95]
v_pk_fma_f32 v[96:97], v[96:97], s[60:61], v[112:113]
v_pk_fma_f32 v[98:99], v[98:99], s[60:61], v[112:113]
v_pk_fma_f32 v[100:101], v[100:101], s[60:61], v[112:113]
v_pk_fma_f32 v[102:103], v[102:103], s[60:61], v[112:113]
v_pk_mul_f32 v[96:97], v[96:97], v[88:89]
v_pk_mul_f32 v[98:99], v[98:99], v[90:91]
v_pk_mul_f32 v[100:101], v[100:101], v[92:93]
v_pk_mul_f32 v[102:103], v[102:103], v[94:95]
v_exp_f32 v96, v96
v_exp_f32 v97, v97
v_exp_f32 v98, v98
v_exp_f32 v99, v99
v_exp_f32 v100, v100
v_exp_f32 v101, v101
v_exp_f32 v102, v102
v_exp_f32 v103, v103
v_pk_add_f32 v[96:97], v[96:97], 1.0 op_sel_hi:[1,0]
v_pk_add_f32 v[98:99], v[98:99], 1.0 op_sel_hi:[1,0]
v_pk_add_f32 v[100:101], v[100:101], 1.0 op_sel_hi:[1,0]
v_pk_add_f32 v[102:103], v[102:103], 1.0 op_sel_hi:[1,0]
v_rcp_f32 v96, v96
v_rcp_f32 v97, v97
v_rcp_f32 v98, v98
v_rcp_f32 v99, v99
v_rcp_f32 v100, v100
v_rcp_f32 v101, v101
v_rcp_f32 v102, v102
v_rcp_f32 v103, v103
v_pk_mul_f32 v[96:97], v[96:97], v[88:89]
v_pk_mul_f32 v[98:99], v[98:99], v[90:91]
v_pk_mul_f32 v[100:101], v[100:101], v[92:93]
v_pk_mul_f32 v[102:103], v[102:103], v[94:95]
v_cvt_pk_bf16_f32 v108, v96, v97
v_cvt_pk_bf16_f32 v109, v98, v99
v_cvt_pk_bf16_f32 v110, v100, v101
v_cvt_pk_bf16_f32 v111, v102, v103
s_add_u32 s53, s52, 62464
buffer_store_dwordx4 v[108:111], v15, s[36:39], s53 offen sc1
v_pk_fma_f32 v[88:89], v[40:41], v[86:87], v[64:65] op_sel:[0,0,0] op_sel_hi:[1,0,1] neg_lo:[0,1,0] neg_hi:[0,1,0]
v_pk_fma_f32 v[90:91], v[42:43], v[86:87], v[66:67] op_sel:[0,0,0] op_sel_hi:[1,0,1] neg_lo:[0,1,0] neg_hi:[0,1,0]
v_pk_fma_f32 v[92:93], v[44:45], v[86:87], v[68:69] op_sel:[0,0,0] op_sel_hi:[1,0,1] neg_lo:[0,1,0] neg_hi:[0,1,0]
v_pk_fma_f32 v[94:95], v[46:47], v[86:87], v[70:71] op_sel:[0,0,0] op_sel_hi:[1,0,1] neg_lo:[0,1,0] neg_hi:[0,1,0]
v_pk_fma_f32 v[88:89], v[176:177], v[82:83], v[88:89] op_sel:[0,0,0] op_sel_hi:[1,0,1]
v_pk_fma_f32 v[90:91], v[178:179], v[82:83], v[90:91] op_sel:[0,0,0] op_sel_hi:[1,0,1]
v_pk_fma_f32 v[92:93], v[180:181], v[82:83], v[92:93] op_sel:[0,0,0] op_sel_hi:[1,0,1]
v_pk_fma_f32 v[94:95], v[182:183], v[82:83], v[94:95] op_sel:[0,0,0] op_sel_hi:[1,0,1]
v_pk_mul_f32 v[96:97], v[88:89], v[88:89]
v_pk_mul_f32 v[98:99], v[90:91], v[90:91]
v_pk_mul_f32 v[100:101], v[92:93], v[92:93]
v_pk_mul_f32 v[102:103], v[94:95], v[94:95]
v_pk_fma_f32 v[96:97], v[96:97], s[60:61], v[112:113]
v_pk_fma_f32 v[98:99], v[98:99], s[60:61], v[112:113]
v_pk_fma_f32 v[100:101], v[100:101], s[60:61], v[112:113]
v_pk_fma_f32 v[102:103], v[102:103], s[60:61], v[112:113]
v_pk_mul_f32 v[96:97], v[96:97], v[88:89]
v_pk_mul_f32 v[98:99], v[98:99], v[90:91]
v_pk_mul_f32 v[100:101], v[100:101], v[92:93]
v_pk_mul_f32 v[102:103], v[102:103], v[94:95]
v_exp_f32 v96, v96
v_exp_f32 v97, v97
v_exp_f32 v98, v98
v_exp_f32 v99, v99
v_exp_f32 v100, v100
v_exp_f32 v101, v101
v_exp_f32 v102, v102
v_exp_f32 v103, v103
v_pk_add_f32 v[96:97], v[96:97], 1.0 op_sel_hi:[1,0]
v_pk_add_f32 v[98:99], v[98:99], 1.0 op_sel_hi:[1,0]
v_pk_add_f32 v[100:101], v[100:101], 1.0 op_sel_hi:[1,0]
v_pk_add_f32 v[102:103], v[102:103], 1.0 op_sel_hi:[1,0]
v_rcp_f32 v96, v96
v_rcp_f32 v97, v97
v_rcp_f32 v98, v98
v_rcp_f32 v99, v99
v_rcp_f32 v100, v100
v_rcp_f32 v101, v101
v_rcp_f32 v102, v102
v_rcp_f32 v103, v103
v_pk_mul_f32 v[96:97], v[96:97], v[88:89]
v_pk_mul_f32 v[98:99], v[98:99], v[90:91]
v_pk_mul_f32 v[100:101], v[100:101], v[92:93]
v_pk_mul_f32 v[102:103], v[102:103], v[94:95]
v_cvt_pk_bf16_f32 v104, v96, v97
v_cvt_pk_bf16_f32 v105, v98, v99
v_cvt_pk_bf16_f32 v106, v100, v101
v_cvt_pk_bf16_f32 v107, v102, v103
s_add_u32 s53, s52, 123904
buffer_store_dwordx4 v[104:107], v15, s[36:39], s53 offen sc1
v_pk_fma_f32 v[88:89], v[40:41], v[86:87], v[64:65] op_sel:[0,1,0] op_sel_hi:[1,1,1] neg_lo:[0,1,0] neg_hi:[0,1,0]
v_pk_fma_f32 v[90:91], v[42:43], v[86:87], v[66:67] op_sel:[0,1,0] op_sel_hi:[1,1,1] neg_lo:[0,1,0] neg_hi:[0,1,0]
v_pk_fma_f32 v[92:93], v[44:45], v[86:87], v[68:69] op_sel:[0,1,0] op_sel_hi:[1,1,1] neg_lo:[0,1,0] neg_hi:[0,1,0]
v_pk_fma_f32 v[94:95], v[46:47], v[86:87], v[70:71] op_sel:[0,1,0] op_sel_hi:[1,1,1] neg_lo:[0,1,0] neg_hi:[0,1,0]
v_pk_fma_f32 v[88:89], v[184:185], v[82:83], v[88:89] op_sel:[0,1,0] op_sel_hi:[1,1,1]
v_pk_fma_f32 v[90:91], v[186:187], v[82:83], v[90:91] op_sel:[0,1,0] op_sel_hi:[1,1,1]
v_pk_fma_f32 v[92:93], v[188:189], v[82:83], v[92:93] op_sel:[0,1,0] op_sel_hi:[1,1,1]
v_pk_fma_f32 v[94:95], v[190:191], v[82:83], v[94:95] op_sel:[0,1,0] op_sel_hi:[1,1,1]
v_pk_mul_f32 v[96:97], v[88:89], v[88:89]
v_pk_mul_f32 v[98:99], v[90:91], v[90:91]
v_pk_mul_f32 v[100:101], v[92:93], v[92:93]
v_pk_mul_f32 v[102:103], v[94:95], v[94:95]
v_pk_fma_f32 v[96:97], v[96:97], s[60:61], v[112:113]
v_pk_fma_f32 v[98:99], v[98:99], s[60:61], v[112:113]
v_pk_fma_f32 v[100:101], v[100:101], s[60:61], v[112:113]
v_pk_fma_f32 v[102:103], v[102:103], s[60:61], v[112:113]
v_pk_mul_f32 v[96:97], v[96:97], v[88:89]
v_pk_mul_f32 v[98:99], v[98:99], v[90:91]
v_pk_mul_f32 v[100:101], v[100:101], v[92:93]
v_pk_mul_f32 v[102:103], v[102:103], v[94:95]
v_exp_f32 v96, v96
v_exp_f32 v97, v97
v_exp_f32 v98, v98
v_exp_f32 v99, v99
v_exp_f32 v100, v100
v_exp_f32 v101, v101
v_exp_f32 v102, v102
v_exp_f32 v103, v103
v_pk_add_f32 v[96:97], v[96:97], 1.0 op_sel_hi:[1,0]
v_pk_add_f32 v[98:99], v[98:99], 1.0 op_sel_hi:[1,0]
v_pk_add_f32 v[100:101], v[100:101], 1.0 op_sel_hi:[1,0]
v_pk_add_f32 v[102:103], v[102:103], 1.0 op_sel_hi:[1,0]
v_rcp_f32 v96, v96
v_rcp_f32 v97, v97
v_rcp_f32 v98, v98
v_rcp_f32 v99, v99
v_rcp_f32 v100, v100
v_rcp_f32 v101, v101
v_rcp_f32 v102, v102
v_rcp_f32 v103, v103
v_pk_mul_f32 v[96:97], v[96:97], v[88:89]
v_pk_mul_f32 v[98:99], v[98:99], v[90:91]
v_pk_mul_f32 v[100:101], v[100:101], v[92:93]
v_pk_mul_f32 v[102:103], v[102:103], v[94:95]
v_cvt_pk_bf16_f32 v108, v96, v97
v_cvt_pk_bf16_f32 v109, v98, v99
v_cvt_pk_bf16_f32 v110, v100, v101
v_cvt_pk_bf16_f32 v111, v102, v103
s_add_u32 s53, s52, 185344
buffer_store_dwordx4 v[108:111], v15, s[36:39], s53 offen sc1
s_cmp_lt_u32 s55, 3
s_cbranch_scc1 L_gelu_done
v_pk_fma_f32 v[88:89], v[48:49], v[84:85], v[72:73] op_sel:[0,0,0] op_sel_hi:[1,0,1] neg_lo:[0,1,0] neg_hi:[0,1,0]
v_pk_fma_f32 v[90:91], v[50:51], v[84:85], v[74:75] op_sel:[0,0,0] op_sel_hi:[1,0,1] neg_lo:[0,1,0] neg_hi:[0,1,0]
v_pk_fma_f32 v[92:93], v[52:53], v[84:85], v[76:77] op_sel:[0,0,0] op_sel_hi:[1,0,1] neg_lo:[0,1,0] neg_hi:[0,1,0]
v_pk_fma_f32 v[94:95], v[54:55], v[84:85], v[78:79] op_sel:[0,0,0] op_sel_hi:[1,0,1] neg_lo:[0,1,0] neg_hi:[0,1,0]
v_pk_fma_f32 v[88:89], v[192:193], v[80:81], v[88:89] op_sel:[0,0,0] op_sel_hi:[1,0,1]
v_pk_fma_f32 v[90:91], v[194:195], v[80:81], v[90:91] op_sel:[0,0,0] op_sel_hi:[1,0,1]
v_pk_fma_f32 v[92:93], v[196:197], v[80:81], v[92:93] op_sel:[0,0,0] op_sel_hi:[1,0,1]
v_pk_fma_f32 v[94:95], v[198:199], v[80:81], v[94:95] op_sel:[0,0,0] op_sel_hi:[1,0,1]
v_pk_mul_f32 v[96:97], v[88:89], v[88:89]
v_pk_mul_f32 v[98:99], v[90:91], v[90:91]
v_pk_mul_f32 v[100:101], v[92:93], v[92:93]
v_pk_mul_f32 v[102:103], v[94:95], v[94:95]
v_pk_fma_f32 v[96:97], v[96:97], s[60:61], v[112:113]
v_pk_fma_f32 v[98:99], v[98:99], s[60:61], v[112:113]
v_pk_fma_f32 v[100:101], v[100:101], s[60:61], v[112:113]
v_pk_fma_f32 v[102:103], v[102:103], s[60:61], v[112:113]
v_pk_mul_f32 v[96:97], v[96:97], v[88:89]
v_pk_mul_f32 v[98:99], v[98:99], v[90:91]
v_pk_mul_f32 v[100:101], v[100:101], v[92:93]
v_pk_mul_f32 v[102:103], v[102:103], v[94:95]
v_exp_f32 v96, v96
v_exp_f32 v97, v97
v_exp_f32 v98, v98
v_exp_f32 v99, v99
v_exp_f32 v100, v100
v_exp_f32 v101, v101
v_exp_f32 v102, v102
v_exp_f32 v103, v103
v_pk_add_f32 v[96:97], v[96:97], 1.0 op_sel_hi:[1,0]
v_pk_add_f32 v[98:99], v[98:99], 1.0 op_sel_hi:[1,0]
v_pk_add_f32 v[100:101], v[100:101], 1.0 op_sel_hi:[1,0]
v_pk_add_f32 v[102:103], v[102:103], 1.0 op_sel_hi:[1,0]
v_rcp_f32 v96, v96
v_rcp_f32 v97, v97
v_rcp_f32 v98, v98
v_rcp_f32 v99, v99
v_rcp_f32 v100, v100
v_rcp_f32 v101, v101
v_rcp_f32 v102, v102
v_rcp_f32 v103, v103
v_pk_mul_f32 v[96:97], v[96:97], v[88:89]
v_pk_mul_f32 v[98:99], v[98:99], v[90:91]
v_pk_mul_f32 v[100:101], v[100:101], v[92:93]
v_pk_mul_f32 v[102:103], v[102:103], v[94:95]
v_cvt_pk_bf16_f32 v104, v96, v97
v_cvt_pk_bf16_f32 v105, v98, v99
v_cvt_pk_bf16_f32 v106, v100, v101
v_cvt_pk_bf16_f32 v107, v102, v103
s_add_u32 s53, s52, 2048
buffer_store_dwordx4 v[104:107], v15, s[36:39], s53 offen sc1
v_pk_fma_f32 v[88:89], v[48:49], v[84:85], v[72:73] op_sel:[0,1,0] op_sel_hi:[1,1,1] neg_lo:[0,1,0] neg_hi:[0,1,0]
v_pk_fma_f32 v[90:91], v[50:51], v[84:85], v[74:75] op_sel:[0,1,0] op_sel_hi:[1,1,1] neg_lo:[0,1,0] neg_hi:[0,1,0]
v_pk_fma_f32 v[92:93], v[52:53], v[84:85], v[76:77] op_sel:[0,1,0] op_sel_hi:[1,1,1] neg_lo:[0,1,0] neg_hi:[0,1,0]
v_pk_fma_f32 v[94:95], v[54:55], v[84:85], v[78:79] op_sel:[0,1,0] op_sel_hi:[1,1,1] neg_lo:[0,1,0] neg_hi:[0,1,0]
v_pk_fma_f32 v[88:89], v[200:201], v[80:81], v[88:89] op_sel:[0,1,0] op_sel_hi:[1,1,1]
v_pk_fma_f32 v[90:91], v[202:203], v[80:81], v[90:91] op_sel:[0,1,0] op_sel_hi:[1,1,1]
v_pk_fma_f32 v[92:93], v[204:205], v[80:81], v[92:93] op_sel:[0,1,0] op_sel_hi:[1,1,1]
v_pk_fma_f32 v[94:95], v[206:207], v[80:81], v[94:95] op_sel:[0,1,0] op_sel_hi:[1,1,1]
v_pk_mul_f32 v[96:97], v[88:89], v[88:89]
v_pk_mul_f32 v[98:99], v[90:91], v[90:91]
v_pk_mul_f32 v[100:101], v[92:93], v[92:93]
v_pk_mul_f32 v[102:103], v[94:95], v[94:95]
v_pk_fma_f32 v[96:97], v[96:97], s[60:61], v[112:113]
v_pk_fma_f32 v[98:99], v[98:99], s[60:61], v[112:113]
v_pk_fma_f32 v[100:101], v[100:101], s[60:61], v[112:113]
v_pk_fma_f32 v[102:103], v[102:103], s[60:61], v[112:113]
v_pk_mul_f32 v[96:97], v[96:97], v[88:89]
v_pk_mul_f32 v[98:99], v[98:99], v[90:91]
v_pk_mul_f32 v[100:101], v[100:101], v[92:93]
v_pk_mul_f32 v[102:103], v[102:103], v[94:95]
v_exp_f32 v96, v96
v_exp_f32 v97, v97
v_exp_f32 v98, v98
v_exp_f32 v99, v99
v_exp_f32 v100, v100
v_exp_f32 v101, v101
v_exp_f32 v102, v102
v_exp_f32 v103, v103
v_pk_add_f32 v[96:97], v[96:97], 1.0 op_sel_hi:[1,0]
v_pk_add_f32 v[98:99], v[98:99], 1.0 op_sel_hi:[1,0]
v_pk_add_f32 v[100:101], v[100:101], 1.0 op_sel_hi:[1,0]
v_pk_add_f32 v[102:103], v[102:103], 1.0 op_sel_hi:[1,0]
v_rcp_f32 v96, v96
v_rcp_f32 v97, v97
v_rcp_f32 v98, v98
v_rcp_f32 v99, v99
v_rcp_f32 v100, v100
v_rcp_f32 v101, v101
v_rcp_f32 v102, v102
v_rcp_f32 v103, v103
v_pk_mul_f32 v[96:97], v[96:97], v[88:89]
v_pk_mul_f32 v[98:99], v[98:99], v[90:91]
v_pk_mul_f32 v[100:101], v[100:101], v[92:93]
v_pk_mul_f32 v[102:103], v[102:103], v[94:95]
v_cvt_pk_bf16_f32 v108, v96, v97
v_cvt_pk_bf16_f32 v109, v98, v99
v_cvt_pk_bf16_f32 v110, v100, v101
v_cvt_pk_bf16_f32 v111, v102, v103
s_add_u32 s53, s52, 63488
buffer_store_dwordx4 v[108:111], v15, s[36:39], s53 offen sc1
v_pk_fma_f32 v[88:89], v[48:49], v[86:87], v[72:73] op_sel:[0,0,0] op_sel_hi:[1,0,1] neg_lo:[0,1,0] neg_hi:[0,1,0]
v_pk_fma_f32 v[90:91], v[50:51], v[86:87], v[74:75] op_sel:[0,0,0] op_sel_hi:[1,0,1] neg_lo:[0,1,0] neg_hi:[0,1,0]
v_pk_fma_f32 v[92:93], v[52:53], v[86:87], v[76:77] op_sel:[0,0,0] op_sel_hi:[1,0,1] neg_lo:[0,1,0] neg_hi:[0,1,0]
v_pk_fma_f32 v[94:95], v[54:55], v[86:87], v[78:79] op_sel:[0,0,0] op_sel_hi:[1,0,1] neg_lo:[0,1,0] neg_hi:[0,1,0]
v_pk_fma_f32 v[88:89], v[208:209], v[82:83], v[88:89] op_sel:[0,0,0] op_sel_hi:[1,0,1]
v_pk_fma_f32 v[90:91], v[210:211], v[82:83], v[90:91] op_sel:[0,0,0] op_sel_hi:[1,0,1]
v_pk_fma_f32 v[92:93], v[212:213], v[82:83], v[92:93] op_sel:[0,0,0] op_sel_hi:[1,0,1]
v_pk_fma_f32 v[94:95], v[214:215], v[82:83], v[94:95] op_sel:[0,0,0] op_sel_hi:[1,0,1]
v_pk_mul_f32 v[96:97], v[88:89], v[88:89]
v_pk_mul_f32 v[98:99], v[90:91], v[90:91]
v_pk_mul_f32 v[100:101], v[92:93], v[92:93]
v_pk_mul_f32 v[102:103], v[94:95], v[94:95]
v_pk_fma_f32 v[96:97], v[96:97], s[60:61], v[112:113]
v_pk_fma_f32 v[98:99], v[98:99], s[60:61], v[112:113]
v_pk_fma_f32 v[100:101], v[100:101], s[60:61], v[112:113]
v_pk_fma_f32 v[102:103], v[102:103], s[60:61], v[112:113]
v_pk_mul_f32 v[96:97], v[96:97], v[88:89]
v_pk_mul_f32 v[98:99], v[98:99], v[90:91]
v_pk_mul_f32 v[100:101], v[100:101], v[92:93]
v_pk_mul_f32 v[102:103], v[102:103], v[94:95]
v_exp_f32 v96, v96
v_exp_f32 v97, v97
v_exp_f32 v98, v98
v_exp_f32 v99, v99
v_exp_f32 v100, v100
v_exp_f32 v101, v101
v_exp_f32 v102, v102
v_exp_f32 v103, v103
v_pk_add_f32 v[96:97], v[96:97], 1.0 op_sel_hi:[1,0]
v_pk_add_f32 v[98:99], v[98:99], 1.0 op_sel_hi:[1,0]
v_pk_add_f32 v[100:101], v[100:101], 1.0 op_sel_hi:[1,0]
v_pk_add_f32 v[102:103], v[102:103], 1.0 op_sel_hi:[1,0]
v_rcp_f32 v96, v96
v_rcp_f32 v97, v97
v_rcp_f32 v98, v98
v_rcp_f32 v99, v99
v_rcp_f32 v100, v100
v_rcp_f32 v101, v101
v_rcp_f32 v102, v102
v_rcp_f32 v103, v103
v_pk_mul_f32 v[96:97], v[96:97], v[88:89]
v_pk_mul_f32 v[98:99], v[98:99], v[90:91]
v_pk_mul_f32 v[100:101], v[100:101], v[92:93]
v_pk_mul_f32 v[102:103], v[102:103], v[94:95]
v_cvt_pk_bf16_f32 v104, v96, v97
v_cvt_pk_bf16_f32 v105, v98, v99
v_cvt_pk_bf16_f32 v106, v100, v101
v_cvt_pk_bf16_f32 v107, v102, v103
s_add_u32 s53, s52, 124928
buffer_store_dwordx4 v[104:107], v15, s[36:39], s53 offen sc1
v_pk_fma_f32 v[88:89], v[48:49], v[86:87], v[72:73] op_sel:[0,1,0] op_sel_hi:[1,1,1] neg_lo:[0,1,0] neg_hi:[0,1,0]
v_pk_fma_f32 v[90:91], v[50:51], v[86:87], v[74:75] op_sel:[0,1,0] op_sel_hi:[1,1,1] neg_lo:[0,1,0] neg_hi:[0,1,0]
v_pk_fma_f32 v[92:93], v[52:53], v[86:87], v[76:77] op_sel:[0,1,0] op_sel_hi:[1,1,1] neg_lo:[0,1,0] neg_hi:[0,1,0]
v_pk_fma_f32 v[94:95], v[54:55], v[86:87], v[78:79] op_sel:[0,1,0] op_sel_hi:[1,1,1] neg_lo:[0,1,0] neg_hi:[0,1,0]
v_pk_fma_f32 v[88:89], v[216:217], v[82:83], v[88:89] op_sel:[0,1,0] op_sel_hi:[1,1,1]
v_pk_fma_f32 v[90:91], v[218:219], v[82:83], v[90:91] op_sel:[0,1,0] op_sel_hi:[1,1,1]
v_pk_fma_f32 v[92:93], v[220:221], v[82:83], v[92:93] op_sel:[0,1,0] op_sel_hi:[1,1,1]
v_pk_fma_f32 v[94:95], v[222:223], v[82:83], v[94:95] op_sel:[0,1,0] op_sel_hi:[1,1,1]
v_pk_mul_f32 v[96:97], v[88:89], v[88:89]
v_pk_mul_f32 v[98:99], v[90:91], v[90:91]
v_pk_mul_f32 v[100:101], v[92:93], v[92:93]
v_pk_mul_f32 v[102:103], v[94:95], v[94:95]
v_pk_fma_f32 v[96:97], v[96:97], s[60:61], v[112:113]
v_pk_fma_f32 v[98:99], v[98:99], s[60:61], v[112:113]
v_pk_fma_f32 v[100:101], v[100:101], s[60:61], v[112:113]
v_pk_fma_f32 v[102:103], v[102:103], s[60:61], v[112:113]
v_pk_mul_f32 v[96:97], v[96:97], v[88:89]
v_pk_mul_f32 v[98:99], v[98:99], v[90:91]
v_pk_mul_f32 v[100:101], v[100:101], v[92:93]
v_pk_mul_f32 v[102:103], v[102:103], v[94:95]
v_exp_f32 v96, v96
v_exp_f32 v97, v97
v_exp_f32 v98, v98
v_exp_f32 v99, v99
v_exp_f32 v100, v100
v_exp_f32 v101, v101
v_exp_f32 v102, v102
v_exp_f32 v103, v103
v_pk_add_f32 v[96:97], v[96:97], 1.0 op_sel_hi:[1,0]
v_pk_add_f32 v[98:99], v[98:99], 1.0 op_sel_hi:[1,0]
v_pk_add_f32 v[100:101], v[100:101], 1.0 op_sel_hi:[1,0]
v_pk_add_f32 v[102:103], v[102:103], 1.0 op_sel_hi:[1,0]
v_rcp_f32 v96, v96
v_rcp_f32 v97, v97
v_rcp_f32 v98, v98
v_rcp_f32 v99, v99
v_rcp_f32 v100, v100
v_rcp_f32 v101, v101
v_rcp_f32 v102, v102
v_rcp_f32 v103, v103
v_pk_mul_f32 v[96:97], v[96:97], v[88:89]
v_pk_mul_f32 v[98:99], v[98:99], v[90:91]
v_pk_mul_f32 v[100:101], v[100:101], v[92:93]
v_pk_mul_f32 v[102:103], v[102:103], v[94:95]
v_cvt_pk_bf16_f32 v108, v96, v97
v_cvt_pk_bf16_f32 v109, v98, v99
v_cvt_pk_bf16_f32 v110, v100, v101
v_cvt_pk_bf16_f32 v111, v102, v103
s_add_u32 s53, s52, 186368
buffer_store_dwordx4 v[108:111], v15, s[36:39], s53 offen sc1
L_gelu_done:
L_p1done:
s_waitcnt vmcnt(0)
s_mov_b32 s40, s24
s_and_b32 s41, s25, 0xffff
s_mov_b32 s42, 8519680
s_mov_b32 s43, 0x20000
v_mov_b32 v2, 151808
v_mov_b32 v3, 1
v_mov_b32 v4, 151552
s_mov_b64 exec, 1
ds_add_rtn_u32 v3, v2, v3
ds_read_b32 v5, v4
s_waitcnt lgkmcnt(0)
s_mov_b64 exec, -1
v_readfirstlane_b32 s52, v3
s_nop 1
s_cmp_lg_u32 s52, 3
s_cbranch_scc1 L_nopub
s_lshl_b32 s52, s27, 4
s_add_u32 s52, s52, s28
s_lshl_b32 s52, s52, 7
s_add_u32 s52, s52, 8454148
v_mov_b32 v2, s52
s_mov_b64 exec, 1
buffer_store_dword v5, v2, s[40:43], 0 offen sc1
s_mov_b64 exec, -1
L_nopub:
v_lshrrev_b32 v6, 2, v8
v_lshl_add_u32 v6, v9, 2, v6
v_lshrrev_b32 v7, 1, v6
v_and_b32 v7, 3, v7
v_lshlrev_b32 v7, 5, v7
v_lshlrev_b32 v6, 7, v6
v_and_b32 v10, 3, v8
v_lshl_add_u32 v6, v10, 3, v6
s_lshl_b32 s52, s26, 12
v_add_u32 v6, s52, v6
v_xor_b32 v10, 0, v7
v_add_u32 v2, v6, v10
v_xor_b32 v10, 32, v7
v_add_u32 v3, v6, v10
v_xor_b32 v10, 64, v7
v_add_u32 v4, v6, v10
v_xor_b32 v10, 96, v7
v_add_u32 v5, v6, v10
L_p2:
s_mov_b32 s44, s24
s_and_b32 s45, s25, 0xffff
s_mov_b32 s46, 8519680
s_mov_b32 s47, 0x20000
v_lshlrev_b32 v1, 4, v0
s_lshl_b32 s56, s32, 2
s_mul_i32 s56, s56, 60
s_add_u32 s56, s56, s26
s_lshl_b32 s56, s56, 10
s_mul_i32 s59, s26, 6
s_mul_i32 s53, s26, 5
s_add_u32 s53, s53, 3
s_cmp_lt_u32 s26, 3
s_cselect_b32 s59, s59, s53
s_lshl_b32 s52, s32, 2
s_mul_i32 s52, s52, 60
s_add_u32 s59, s59, s52
s_add_u32 s59, s59, 16
s_lshl_b32 s59, s59, 10
s_add_u32 s57, s59, 5120
s_cmp_lt_u32 s26, 3
s_cselect_b32 s57, s57, 0x80000000
s_cmp_lt_u32 s26, 4
s_cbranch_scc1 L_np
s_setprio 1
L_np:
s_barrier
s_lshr_b32 s64, s26, 1
s_add_u32 s65, s64, 4
s_add_u32 s66, s26, 8
s_add_u32 s67, s26, 8
s_add_u32 s68, s26, 8
s_add_u32 s69, s26, 8
s_add_u32 s70, s26, 8
s_add_u32 s71, s26, 8
s_cmp_lg_u32 s26, 4
s_cbranch_scc1 L_fnp
s_mov_b32 s61, 65536
L_fpl:
s_cmp_eq_u32 s60, 0xffff
s_cbranch_scc1 L_fnp
s_mov_b64 exec, 0xffff
buffer_load_dword v7, v6, s[44:47], 0 offen sc1
s_waitcnt vmcnt(0)
v_cmp_eq_u32 vcc, s97, v7
s_mov_b64 exec, -1
s_nop 0
s_mov_b32 s60, vcc_lo
v_mov_b32 v11, s60
ds_write_b32 v10, v11
s_sub_u32 s61, s61, 1
s_cmp_lg_u32 s61, 0
s_cbranch_scc1 L_fpl
L_fnp:
v_mov_b32 v10, 151820
s_mov_b32 s72, 0
s_cmp_ge_u32 s26, 4
s_cbranch_scc1 L_wrdy
ds_read_b64_tr_b16 v[124:125], v2 offset:0
ds_read_b64_tr_b16 v[126:127], v2 offset:2048
ds_read_b64_tr_b16 v[128:129], v3 offset:0
ds_read_b64_tr_b16 v[130:131], v3 offset:2048
ds_read_b64_tr_b16 v[132:133], v4 offset:0
ds_read_b64_tr_b16 v[134:135], v4 offset:2048
ds_read_b64_tr_b16 v[136:137], v5 offset:0
ds_read_b64_tr_b16 v[138:139], v5 offset:2048
ds_read_b64_tr_b16 v[140:141], v2 offset:16384
ds_read_b64_tr_b16 v[142:143], v2 offset:18432
ds_read_b64_tr_b16 v[144:145], v3 offset:16384
ds_read_b64_tr_b16 v[146:147], v3 offset:18432
ds_read_b64_tr_b16 v[148:149], v4 offset:16384
ds_read_b64_tr_b16 v[150:151], v4 offset:18432
ds_read_b64_tr_b16 v[152:153], v5 offset:16384
ds_read_b64_tr_b16 v[154:155], v5 offset:18432
ds_read_b64_tr_b16 v[156:157], v2 offset:32768
ds_read_b64_tr_b16 v[158:159], v2 offset:34816
ds_read_b64_tr_b16 v[160:161], v3 offset:32768
ds_read_b64_tr_b16 v[162:163], v3 offset:34816
ds_read_b64_tr_b16 v[164:165], v4 offset:32768
ds_read_b64_tr_b16 v[166:167], v4 offset:34816
ds_read_b64_tr_b16 v[168:169], v5 offset:32768
ds_read_b64_tr_b16 v[170:171], v5 offset:34816
ds_read_b64_tr_b16 v[172:173], v2 offset:49152
ds_read_b64_tr_b16 v[174:175], v2 offset:51200
ds_read_b64_tr_b16 v[176:177], v3 offset:49152
ds_read_b64_tr_b16 v[178:179], v3 offset:51200
ds_read_b64_tr_b16 v[180:181], v4 offset:49152
ds_read_b64_tr_b16 v[182:183], v4 offset:51200
ds_read_b64_tr_b16 v[184:185], v5 offset:49152
ds_read_b64_tr_b16 v[186:187], v5 offset:51200
v_add_u32 v2, 65536, v2
v_add_u32 v3, 65536, v3
v_add_u32 v4, 65536, v4
v_add_u32 v5, 65536, v5
ds_read_b64_tr_b16 v[188:189], v2 offset:0
ds_read_b64_tr_b16 v[190:191], v2 offset:2048
ds_read_b64_tr_b16 v[192:193], v3 offset:0
ds_read_b64_tr_b16 v[194:195], v3 offset:2048
ds_read_b64_tr_b16 v[196:197], v4 offset:0
ds_read_b64_tr_b16 v[198:199], v4 offset:2048
ds_read_b64_tr_b16 v[200:201], v5 offset:0
ds_read_b64_tr_b16 v[202:203], v5 offset:2048
ds_read_b64_tr_b16 v[204:205], v2 offset:16384
ds_read_b64_tr_b16 v[206:207], v2 offset:18432
ds_read_b64_tr_b16 v[208:209], v3 offset:16384
ds_read_b64_tr_b16 v[210:211], v3 offset:18432
ds_read_b64_tr_b16 v[212:213], v4 offset:16384
ds_read_b64_tr_b16 v[214:215], v4 offset:18432
ds_read_b64_tr_b16 v[216:217], v5 offset:16384
ds_read_b64_tr_b16 v[218:219], v5 offset:18432
ds_read_b64_tr_b16 v[220:221], v2 offset:32768
ds_read_b64_tr_b16 v[222:223], v2 offset:34816
ds_read_b64_tr_b16 v[224:225], v3 offset:32768
ds_read_b64_tr_b16 v[226:227], v3 offset:34816
ds_read_b64_tr_b16 v[228:229], v4 offset:32768
ds_read_b64_tr_b16 v[230:231], v4 offset:34816
ds_read_b64_tr_b16 v[232:233], v5 offset:32768
ds_read_b64_tr_b16 v[234:235], v5 offset:34816
ds_read_b64_tr_b16 v[236:237], v2 offset:49152
ds_read_b64_tr_b16 v[238:239], v2 offset:51200
ds_read_b64_tr_b16 v[240:241], v3 offset:49152
ds_read_b64_tr_b16 v[242:243], v3 offset:51200
ds_read_b64_tr_b16 v[244:245], v4 offset:49152
ds_read_b64_tr_b16 v[246:247], v4 offset:51200
ds_read_b64_tr_b16 v[248:249], v5 offset:49152
ds_read_b64_tr_b16 v[250:251], v5 offset:51200
s_waitcnt lgkmcnt(0)
L_wrdy:
s_bitcmp1_b32 s72, s64
s_cbranch_scc0 L_gw0
L_gr0:
s_add_u32 s58, s56, 0
buffer_load_dwordx4 v[12:15], v1, s[44:47], s58 offen sc1
s_add_u32 s58, s56, 61440
buffer_load_dwordx4 v[16:19], v1, s[44:47], s58 offen sc1
s_add_u32 s58, s56, 122880
buffer_load_dwordx4 v[20:23], v1, s[44:47], s58 offen sc1
s_add_u32 s58, s56, 184320
buffer_load_dwordx4 v[24:27], v1, s[44:47], s58 offen sc1
s_bitcmp1_b32 s72, s65
s_cbranch_scc0 L_gw1
L_gr1:
s_add_u32 s58, s56, 8192
buffer_load_dwordx4 v[28:31], v1, s[44:47], s58 offen sc1
s_add_u32 s58, s56, 69632
buffer_load_dwordx4 v[32:35], v1, s[44:47], s58 offen sc1
s_add_u32 s58, s56, 131072
buffer_load_dwordx4 v[36:39], v1, s[44:47], s58 offen sc1
s_add_u32 s58, s56, 192512
buffer_load_dwordx4 v[40:43], v1, s[44:47], s58 offen sc1
s_bitcmp1_b32 s72, s66
s_cbranch_scc0 L_gw2
L_gr2:
s_add_u32 s58, s59, 0
buffer_load_dwordx4 v[44:47], v1, s[44:47], s58 offen sc1
s_add_u32 s58, s59, 61440
buffer_load_dwordx4 v[48:51], v1, s[44:47], s58 offen sc1
s_add_u32 s58, s59, 122880
buffer_load_dwordx4 v[52:55], v1, s[44:47], s58 offen sc1
s_add_u32 s58, s59, 184320
buffer_load_dwordx4 v[56:59], v1, s[44:47], s58 offen sc1
s_waitcnt vmcnt(8)
v_mfma_f32_16x16x32_bf16 v[60:63], v[12:15], v[124:127], 0
v_mfma_f32_16x16x32_bf16 v[76:79], v[12:15], v[128:131], 0
v_mfma_f32_16x16x32_bf16 v[92:95], v[12:15], v[132:135], 0
v_mfma_f32_16x16x32_bf16 v[108:111], v[12:15], v[136:139], 0
v_mfma_f32_16x16x32_bf16 v[64:67], v[16:19], v[124:127], 0
v_mfma_f32_16x16x32_bf16 v[80:83], v[16:19], v[128:131], 0
v_mfma_f32_16x16x32_bf16 v[96:99], v[16:19], v[132:135], 0
v_mfma_f32_16x16x32_bf16 v[112:115], v[16:19], v[136:139], 0
v_mfma_f32_16x16x32_bf16 v[68:71], v[20:23], v[124:127], 0
v_mfma_f32_16x16x32_bf16 v[84:87], v[20:23], v[128:131], 0
v_mfma_f32_16x16x32_bf16 v[100:103], v[20:23], v[132:135], 0
v_mfma_f32_16x16x32_bf16 v[116:119], v[20:23], v[136:139], 0
v_mfma_f32_16x16x32_bf16 v[72:75], v[24:27], v[124:127], 0
v_mfma_f32_16x16x32_bf16 v[88:91], v[24:27], v[128:131], 0
v_mfma_f32_16x16x32_bf16 v[104:107], v[24:27], v[132:135], 0
v_mfma_f32_16x16x32_bf16 v[120:123], v[24:27], v[136:139], 0
s_bitcmp1_b32 s72, s67
s_cbranch_scc0 L_gw3
L_gr3:
s_add_u32 s58, s59, 3072
buffer_load_dwordx4 v[12:15], v1, s[44:47], s58 offen sc1
s_add_u32 s58, s59, 64512
buffer_load_dwordx4 v[16:19], v1, s[44:47], s58 offen sc1
s_add_u32 s58, s59, 125952
buffer_load_dwordx4 v[20:23], v1, s[44:47], s58 offen sc1
s_add_u32 s58, s59, 187392
buffer_load_dwordx4 v[24:27], v1, s[44:47], s58 offen sc1
s_waitcnt vmcnt(8)
v_mfma_f32_16x16x32_bf16 v[60:63], v[28:31], v[140:143], v[60:63]
v_mfma_f32_16x16x32_bf16 v[76:79], v[28:31], v[144:147], v[76:79]
v_mfma_f32_16x16x32_bf16 v[92:95], v[28:31], v[148:151], v[92:95]
v_mfma_f32_16x16x32_bf16 v[108:111], v[28:31], v[152:155], v[108:111]
v_mfma_f32_16x16x32_bf16 v[64:67], v[32:35], v[140:143], v[64:67]
v_mfma_f32_16x16x32_bf16 v[80:83], v[32:35], v[144:147], v[80:83]
v_mfma_f32_16x16x32_bf16 v[96:99], v[32:35], v[148:151], v[96:99]
v_mfma_f32_16x16x32_bf16 v[112:115], v[32:35], v[152:155], v[112:115]
v_mfma_f32_16x16x32_bf16 v[68:71], v[36:39], v[140:143], v[68:71]
v_mfma_f32_16x16x32_bf16 v[84:87], v[36:39], v[144:147], v[84:87]
v_mfma_f32_16x16x32_bf16 v[100:103], v[36:39], v[148:151], v[100:103]
v_mfma_f32_16x16x32_bf16 v[116:119], v[36:39], v[152:155], v[116:119]
v_mfma_f32_16x16x32_bf16 v[72:75], v[40:43], v[140:143], v[72:75]
v_mfma_f32_16x16x32_bf16 v[88:91], v[40:43], v[144:147], v[88:91]
v_mfma_f32_16x16x32_bf16 v[104:107], v[40:43], v[148:151], v[104:107]
v_mfma_f32_16x16x32_bf16 v[120:123], v[40:43], v[152:155], v[120:123]
s_bitcmp1_b32 s72, s68
s_cbranch_scc0 L_gw4
L_gr4:
s_add_u32 s58, s59, 1024
buffer_load_dwordx4 v[124:127], v1, s[44:47], s58 offen sc1
s_add_u32 s58, s59, 62464
buffer_load_dwordx4 v[128:131], v1, s[44:47], s58 offen sc1
s_add_u32 s58, s59, 123904
buffer_load_dwordx4 v[132:135], v1, s[44:47], s58 offen sc1
s_add_u32 s58, s59, 185344
buffer_load_dwordx4 v[136:139], v1, s[44:47], s58 offen sc1
s_waitcnt vmcnt(8)
v_mfma_f32_16x16x32_bf16 v[60:63], v[44:47], v[156:159], v[60:63]
v_mfma_f32_16x16x32_bf16 v[76:79], v[44:47], v[160:163], v[76:79]
v_mfma_f32_16x16x32_bf16 v[92:95], v[44:47], v[164:167], v[92:95]
v_mfma_f32_16x16x32_bf16 v[108:111], v[44:47], v[168:171], v[108:111]
v_mfma_f32_16x16x32_bf16 v[64:67], v[48:51], v[156:159], v[64:67]
v_mfma_f32_16x16x32_bf16 v[80:83], v[48:51], v[160:163], v[80:83]
v_mfma_f32_16x16x32_bf16 v[96:99], v[48:51], v[164:167], v[96:99]
v_mfma_f32_16x16x32_bf16 v[112:115], v[48:51], v[168:171], v[112:115]
v_mfma_f32_16x16x32_bf16 v[68:71], v[52:55], v[156:159], v[68:71]
v_mfma_f32_16x16x32_bf16 v[84:87], v[52:55], v[160:163], v[84:87]
v_mfma_f32_16x16x32_bf16 v[100:103], v[52:55], v[164:167], v[100:103]
v_mfma_f32_16x16x32_bf16 v[116:119], v[52:55], v[168:171], v[116:119]
v_mfma_f32_16x16x32_bf16 v[72:75], v[56:59], v[156:159], v[72:75]
v_mfma_f32_16x16x32_bf16 v[88:91], v[56:59], v[160:163], v[88:91]
v_mfma_f32_16x16x32_bf16 v[104:107], v[56:59], v[164:167], v[104:107]
v_mfma_f32_16x16x32_bf16 v[120:123], v[56:59], v[168:171], v[120:123]
s_bitcmp1_b32 s72, s69
s_cbranch_scc0 L_gw5
L_gr5:
s_add_u32 s58, s59, 4096
buffer_load_dwordx4 v[28:31], v1, s[44:47], s58 offen sc1
s_add_u32 s58, s59, 65536
buffer_load_dwordx4 v[32:35], v1, s[44:47], s58 offen sc1
s_add_u32 s58, s59, 126976
buffer_load_dwordx4 v[36:39], v1, s[44:47], s58 offen sc1
s_add_u32 s58, s59, 188416
buffer_load_dwordx4 v[40:43], v1, s[44:47], s58 offen sc1
s_waitcnt vmcnt(8)
v_mfma_f32_16x16x32_bf16 v[60:63], v[12:15], v[172:175], v[60:63]
v_mfma_f32_16x16x32_bf16 v[76:79], v[12:15], v[176:179], v[76:79]
v_mfma_f32_16x16x32_bf16 v[92:95], v[12:15], v[180:183], v[92:95]
v_mfma_f32_16x16x32_bf16 v[108:111], v[12:15], v[184:187], v[108:111]
v_mfma_f32_16x16x32_bf16 v[64:67], v[16:19], v[172:175], v[64:67]
v_mfma_f32_16x16x32_bf16 v[80:83], v[16:19], v[176:179], v[80:83]
v_mfma_f32_16x16x32_bf16 v[96:99], v[16:19], v[180:183], v[96:99]
v_mfma_f32_16x16x32_bf16 v[112:115], v[16:19], v[184:187], v[112:115]
v_mfma_f32_16x16x32_bf16 v[68:71], v[20:23], v[172:175], v[68:71]
v_mfma_f32_16x16x32_bf16 v[84:87], v[20:23], v[176:179], v[84:87]
v_mfma_f32_16x16x32_bf16 v[100:103], v[20:23], v[180:183], v[100:103]
v_mfma_f32_16x16x32_bf16 v[116:119], v[20:23], v[184:187], v[116:119]
v_mfma_f32_16x16x32_bf16 v[72:75], v[24:27], v[172:175], v[72:75]
v_mfma_f32_16x16x32_bf16 v[88:91], v[24:27], v[176:179], v[88:91]
v_mfma_f32_16x16x32_bf16 v[104:107], v[24:27], v[180:183], v[104:107]
v_mfma_f32_16x16x32_bf16 v[120:123], v[24:27], v[184:187], v[120:123]
s_setprio 0
s_bitcmp1_b32 s72, s70
s_cbranch_scc0 L_gw6
L_gr6:
s_add_u32 s58, s59, 2048
buffer_load_dwordx4 v[140:143], v1, s[44:47], s58 offen sc1
s_add_u32 s58, s59, 63488
buffer_load_dwordx4 v[144:147], v1, s[44:47], s58 offen sc1
s_add_u32 s58, s59, 124928
buffer_load_dwordx4 v[148:151], v1, s[44:47], s58 offen sc1
s_add_u32 s58, s59, 186368
buffer_load_dwordx4 v[152:155], v1, s[44:47], s58 offen sc1
s_waitcnt vmcnt(8)
v_mfma_f32_16x16x32_bf16 v[60:63], v[124:127], v[188:191], v[60:63]
v_mfma_f32_16x16x32_bf16 v[76:79], v[124:127], v[192:195], v[76:79]
v_mfma_f32_16x16x32_bf16 v[92:95], v[124:127], v[196:199], v[92:95]
v_mfma_f32_16x16x32_bf16 v[108:111], v[124:127], v[200:203], v[108:111]
v_mfma_f32_16x16x32_bf16 v[64:67], v[128:131], v[188:191], v[64:67]
v_mfma_f32_16x16x32_bf16 v[80:83], v[128:131], v[192:195], v[80:83]
v_mfma_f32_16x16x32_bf16 v[96:99], v[128:131], v[196:199], v[96:99]
v_mfma_f32_16x16x32_bf16 v[112:115], v[128:131], v[200:203], v[112:115]
v_mfma_f32_16x16x32_bf16 v[68:71], v[132:135], v[188:191], v[68:71]
v_mfma_f32_16x16x32_bf16 v[84:87], v[132:135], v[192:195], v[84:87]
v_mfma_f32_16x16x32_bf16 v[100:103], v[132:135], v[196:199], v[100:103]
v_mfma_f32_16x16x32_bf16 v[116:119], v[132:135], v[200:203], v[116:119]
v_mfma_f32_16x16x32_bf16 v[72:75], v[136:139], v[188:191], v[72:75]
v_mfma_f32_16x16x32_bf16 v[88:91], v[136:139], v[192:195], v[88:91]
v_mfma_f32_16x16x32_bf16 v[104:107], v[136:139], v[196:199], v[104:107]
v_mfma_f32_16x16x32_bf16 v[120:123], v[136:139], v[200:203], v[120:123]
s_bitcmp1_b32 s72, s71
s_cbranch_scc0 L_gw7
L_gr7:
s_add_u32 s58, s57, 0
buffer_load_dwordx4 v[44:47], v1, s[44:47], s58 offen sc1
s_add_u32 s58, s57, 61440
buffer_load_dwordx4 v[48:51], v1, s[44:47], s58 offen sc1
s_add_u32 s58, s57, 122880
buffer_load_dwordx4 v[52:55], v1, s[44:47], s58 offen sc1
s_add_u32 s58, s57, 184320
buffer_load_dwordx4 v[56:59], v1, s[44:47], s58 offen sc1
s_mov_b32 s40, s4
s_and_b32 s41, s5, 0xffff
s_mov_b32 s42, 2097152
s_mov_b32 s43, 0x20000
s_mov_b32 s48, s18
s_and_b32 s49, s19, 0xffff
s_mov_b32 s50, 1024
s_mov_b32 s51, 0x20000
v_bfe_u32 v157, v0, 2, 2
v_lshrrev_b32 v158, 4, v0
v_lshl_add_u32 v159, v157, 2, v158
s_lshr_b32 s52, s26, 2
s_lshl_b32 s52, s52, 5
s_lshl_b32 s53, s32, 6
s_add_u32 s52, s52, s53
v_add_u32 v159, s52, v159
v_lshlrev_b32 v159, 10, v159
s_and_b32 s52, s26, 3
s_lshl_b32 s52, s52, 5
s_lshl_b32 s53, s33, 7
s_add_u32 s52, s52, s53
v_and_b32 v160, 3, v0
v_lshl_add_u32 v160, v160, 3, s52
v_add_u32 v156, v159, v160
buffer_load_dwordx2 v[164:165], v156, s[40:43], 0 offen
s_mov_b32 s52, 16384
buffer_load_dwordx2 v[166:167], v156, s[40:43], s52 offen
buffer_load_dwordx2 v[168:169], v160, s[48:51], 0 offen
s_waitcnt vmcnt(11)
v_mfma_f32_16x16x32_bf16 v[60:63], v[28:31], v[204:207], v[60:63]
v_mfma_f32_16x16x32_bf16 v[76:79], v[28:31], v[208:211], v[76:79]
v_mfma_f32_16x16x32_bf16 v[92:95], v[28:31], v[212:215], v[92:95]
v_mfma_f32_16x16x32_bf16 v[108:111], v[28:31], v[216:219], v[108:111]
v_mfma_f32_16x16x32_bf16 v[64:67], v[32:35], v[204:207], v[64:67]
v_mfma_f32_16x16x32_bf16 v[80:83], v[32:35], v[208:211], v[80:83]
v_mfma_f32_16x16x32_bf16 v[96:99], v[32:35], v[212:215], v[96:99]
v_mfma_f32_16x16x32_bf16 v[112:115], v[32:35], v[216:219], v[112:115]
v_mfma_f32_16x16x32_bf16 v[68:71], v[36:39], v[204:207], v[68:71]
v_mfma_f32_16x16x32_bf16 v[84:87], v[36:39], v[208:211], v[84:87]
v_mfma_f32_16x16x32_bf16 v[100:103], v[36:39], v[212:215], v[100:103]
v_mfma_f32_16x16x32_bf16 v[116:119], v[36:39], v[216:219], v[116:119]
v_mfma_f32_16x16x32_bf16 v[72:75], v[40:43], v[204:207], v[72:75]
v_mfma_f32_16x16x32_bf16 v[88:91], v[40:43], v[208:211], v[88:91]
v_mfma_f32_16x16x32_bf16 v[104:107], v[40:43], v[212:215], v[104:107]
v_mfma_f32_16x16x32_bf16 v[120:123], v[40:43], v[216:219], v[120:123]
s_waitcnt vmcnt(7)
v_mfma_f32_16x16x32_bf16 v[60:63], v[140:143], v[220:223], v[60:63]
v_mfma_f32_16x16x32_bf16 v[76:79], v[140:143], v[224:227], v[76:79]
v_mfma_f32_16x16x32_bf16 v[92:95], v[140:143], v[228:231], v[92:95]
v_mfma_f32_16x16x32_bf16 v[108:111], v[140:143], v[232:235], v[108:111]
v_mfma_f32_16x16x32_bf16 v[64:67], v[144:147], v[220:223], v[64:67]
v_mfma_f32_16x16x32_bf16 v[80:83], v[144:147], v[224:227], v[80:83]
v_mfma_f32_16x16x32_bf16 v[96:99], v[144:147], v[228:231], v[96:99]
v_mfma_f32_16x16x32_bf16 v[112:115], v[144:147], v[232:235], v[112:115]
v_mfma_f32_16x16x32_bf16 v[68:71], v[148:151], v[220:223], v[68:71]
v_mfma_f32_16x16x32_bf16 v[84:87], v[148:151], v[224:227], v[84:87]
v_mfma_f32_16x16x32_bf16 v[100:103], v[148:151], v[228:231], v[100:103]
v_mfma_f32_16x16x32_bf16 v[116:119], v[148:151], v[232:235], v[116:119]
v_mfma_f32_16x16x32_bf16 v[72:75], v[152:155], v[220:223], v[72:75]
v_mfma_f32_16x16x32_bf16 v[88:91], v[152:155], v[224:227], v[88:91]
v_mfma_f32_16x16x32_bf16 v[104:107], v[152:155], v[228:231], v[104:107]
v_mfma_f32_16x16x32_bf16 v[120:123], v[152:155], v[232:235], v[120:123]
s_waitcnt vmcnt(3)
s_cmp_ge_u32 s26, 3
s_cbranch_scc1 L_s7skip
v_mfma_f32_16x16x32_bf16 v[60:63], v[44:47], v[236:239], v[60:63]
v_mfma_f32_16x16x32_bf16 v[76:79], v[44:47], v[240:243], v[76:79]
v_mfma_f32_16x16x32_bf16 v[92:95], v[44:47], v[244:247], v[92:95]
v_mfma_f32_16x16x32_bf16 v[108:111], v[44:47], v[248:251], v[108:111]
v_mfma_f32_16x16x32_bf16 v[64:67], v[48:51], v[236:239], v[64:67]
v_mfma_f32_16x16x32_bf16 v[80:83], v[48:51], v[240:243], v[80:83]
v_mfma_f32_16x16x32_bf16 v[96:99], v[48:51], v[244:247], v[96:99]
v_mfma_f32_16x16x32_bf16 v[112:115], v[48:51], v[248:251], v[112:115]
v_mfma_f32_16x16x32_bf16 v[68:71], v[52:55], v[236:239], v[68:71]
v_mfma_f32_16x16x32_bf16 v[84:87], v[52:55], v[240:243], v[84:87]
v_mfma_f32_16x16x32_bf16 v[100:103], v[52:55], v[244:247], v[100:103]
v_mfma_f32_16x16x32_bf16 v[116:119], v[52:55], v[248:251], v[116:119]
v_mfma_f32_16x16x32_bf16 v[72:75], v[56:59], v[236:239], v[72:75]
v_mfma_f32_16x16x32_bf16 v[88:91], v[56:59], v[240:243], v[88:91]
v_mfma_f32_16x16x32_bf16 v[104:107], v[56:59], v[244:247], v[104:107]
v_mfma_f32_16x16x32_bf16 v[120:123], v[56:59], v[248:251], v[120:123]
s_branch L_s7skip
L_gw0:
s_mov_b32 s61, 1048576
L_gl0:
ds_read_b32 v11, v10
s_waitcnt lgkmcnt(0)
v_readfirstlane_b32 s72, v11
s_nop 1
s_bitcmp1_b32 s72, s64
s_cbranch_scc1 L_gr0
s_sub_u32 s61, s61, 1
s_cmp_lg_u32 s61, 0
s_cbranch_scc1 L_gl0
s_branch L_gr0
L_gw1:
s_mov_b32 s61, 1048576
L_gl1:
ds_read_b32 v11, v10
s_waitcnt lgkmcnt(0)
v_readfirstlane_b32 s72, v11
s_nop 1
s_bitcmp1_b32 s72, s65
s_cbranch_scc1 L_gr1
s_sub_u32 s61, s61, 1
s_cmp_lg_u32 s61, 0
s_cbranch_scc1 L_gl1
s_branch L_gr1
L_gw2:
s_mov_b32 s61, 1048576
L_gl2:
ds_read_b32 v11, v10
s_waitcnt lgkmcnt(0)
v_readfirstlane_b32 s72, v11
s_nop 1
s_bitcmp1_b32 s72, s66
s_cbranch_scc1 L_gr2
s_sub_u32 s61, s61, 1
s_cmp_lg_u32 s61, 0
s_cbranch_scc1 L_gl2
s_branch L_gr2
L_gw3:
s_mov_b32 s61, 1048576
L_gl3:
ds_read_b32 v11, v10
s_waitcnt lgkmcnt(0)
v_readfirstlane_b32 s72, v11
s_nop 1
s_bitcmp1_b32 s72, s67
s_cbranch_scc1 L_gr3
s_sub_u32 s61, s61, 1
s_cmp_lg_u32 s61, 0
s_cbranch_scc1 L_gl3
s_branch L_gr3
L_gw4:
s_mov_b32 s61, 1048576
L_gl4:
ds_read_b32 v11, v10
s_waitcnt lgkmcnt(0)
v_readfirstlane_b32 s72, v11
s_nop 1
s_bitcmp1_b32 s72, s68
s_cbranch_scc1 L_gr4
s_sub_u32 s61, s61, 1
s_cmp_lg_u32 s61, 0
s_cbranch_scc1 L_gl4
s_branch L_gr4
L_gw5:
s_mov_b32 s61, 1048576
L_gl5:
ds_read_b32 v11, v10
s_waitcnt lgkmcnt(0)
v_readfirstlane_b32 s72, v11
s_nop 1
s_bitcmp1_b32 s72, s69
s_cbranch_scc1 L_gr5
s_sub_u32 s61, s61, 1
s_cmp_lg_u32 s61, 0
s_cbranch_scc1 L_gl5
s_branch L_gr5
L_gw6:
s_mov_b32 s61, 1048576
L_gl6:
ds_read_b32 v11, v10
s_waitcnt lgkmcnt(0)
v_readfirstlane_b32 s72, v11
s_nop 1
s_bitcmp1_b32 s72, s70
s_cbranch_scc1 L_gr6
s_sub_u32 s61, s61, 1
s_cmp_lg_u32 s61, 0
s_cbranch_scc1 L_gl6
s_branch L_gr6
L_gw7:
s_mov_b32 s61, 1048576
L_gl7:
ds_read_b32 v11, v10
s_waitcnt lgkmcnt(0)
v_readfirstlane_b32 s72, v11
s_nop 1
s_bitcmp1_b32 s72, s71
s_cbranch_scc1 L_gr7
s_sub_u32 s61, s61, 1
s_cmp_lg_u32 s61, 0
s_cbranch_scc1 L_gl7
s_branch L_gr7
L_s7skip:
s_lshl_b32 s52, s26, 14
s_cmp_ge_u32 s26, 4
s_cselect_b32 s53, 49216, 0
s_sub_u32 s52, s52, s53
s_mov_b32 m0, s52
s_nop 5
s_cmp_ge_u32 s26, 4
s_cbranch_scc1 L_wrhi
ds_write_addtid_b32 v60 offset:0
ds_write_addtid_b32 v61 offset:256
ds_write_addtid_b32 v62 offset:512
ds_write_addtid_b32 v63 offset:768
ds_write_addtid_b32 v64 offset:1024
ds_write_addtid_b32 v65 offset:1280
ds_write_addtid_b32 v66 offset:1536
ds_write_addtid_b32 v67 offset:1792
ds_write_addtid_b32 v68 offset:2048
ds_write_addtid_b32 v69 offset:2304
ds_write_addtid_b32 v70 offset:2560
ds_write_addtid_b32 v71 offset:2816
ds_write_addtid_b32 v72 offset:3072
ds_write_addtid_b32 v73 offset:3328
ds_write_addtid_b32 v74 offset:3584
ds_write_addtid_b32 v75 offset:3840
ds_write_addtid_b32 v76 offset:4096
ds_write_addtid_b32 v77 offset:4352
ds_write_addtid_b32 v78 offset:4608
ds_write_addtid_b32 v79 offset:4864
ds_write_addtid_b32 v80 offset:5120
ds_write_addtid_b32 v81 offset:5376
ds_write_addtid_b32 v82 offset:5632
ds_write_addtid_b32 v83 offset:5888
ds_write_addtid_b32 v84 offset:6144
ds_write_addtid_b32 v85 offset:6400
ds_write_addtid_b32 v86 offset:6656
ds_write_addtid_b32 v87 offset:6912
ds_write_addtid_b32 v88 offset:7168
ds_write_addtid_b32 v89 offset:7424
ds_write_addtid_b32 v90 offset:7680
ds_write_addtid_b32 v91 offset:7936
ds_write_addtid_b32 v92 offset:8192
ds_write_addtid_b32 v93 offset:8448
ds_write_addtid_b32 v94 offset:8704
ds_write_addtid_b32 v95 offset:8960
ds_write_addtid_b32 v96 offset:9216
ds_write_addtid_b32 v97 offset:9472
ds_write_addtid_b32 v98 offset:9728
ds_write_addtid_b32 v99 offset:9984
ds_write_addtid_b32 v100 offset:10240
ds_write_addtid_b32 v101 offset:10496
ds_write_addtid_b32 v102 offset:10752
ds_write_addtid_b32 v103 offset:11008
ds_write_addtid_b32 v104 offset:11264
ds_write_addtid_b32 v105 offset:11520
ds_write_addtid_b32 v106 offset:11776
ds_write_addtid_b32 v107 offset:12032
ds_write_addtid_b32 v108 offset:12288
ds_write_addtid_b32 v109 offset:12544
ds_write_addtid_b32 v110 offset:12800
ds_write_addtid_b32 v111 offset:13056
ds_write_addtid_b32 v112 offset:13312
ds_write_addtid_b32 v113 offset:13568
ds_write_addtid_b32 v114 offset:13824
ds_write_addtid_b32 v115 offset:14080
ds_write_addtid_b32 v116 offset:14336
ds_write_addtid_b32 v117 offset:14592
ds_write_addtid_b32 v118 offset:14848
ds_write_addtid_b32 v119 offset:15104
ds_write_addtid_b32 v120 offset:15360
ds_write_addtid_b32 v121 offset:15616
ds_write_addtid_b32 v122 offset:15872
ds_write_addtid_b32 v123 offset:16128
s_branch L_wrd
L_wrhi:
ds_write_addtid_b32 v60 offset:49216
ds_write_addtid_b32 v61 offset:49472
ds_write_addtid_b32 v62 offset:49728
ds_write_addtid_b32 v63 offset:49984
ds_write_addtid_b32 v64 offset:50240
ds_write_addtid_b32 v65 offset:50496
ds_write_addtid_b32 v66 offset:50752
ds_write_addtid_b32 v67 offset:51008
ds_write_addtid_b32 v68 offset:51264
ds_write_addtid_b32 v69 offset:51520
ds_write_addtid_b32 v70 offset:51776
ds_write_addtid_b32 v71 offset:52032
ds_write_addtid_b32 v72 offset:52288
ds_write_addtid_b32 v73 offset:52544
ds_write_addtid_b32 v74 offset:52800
ds_write_addtid_b32 v75 offset:53056
ds_write_addtid_b32 v76 offset:53312
ds_write_addtid_b32 v77 offset:53568
ds_write_addtid_b32 v78 offset:53824
ds_write_addtid_b32 v79 offset:54080
ds_write_addtid_b32 v80 offset:54336
ds_write_addtid_b32 v81 offset:54592
ds_write_addtid_b32 v82 offset:54848
ds_write_addtid_b32 v83 offset:55104
ds_write_addtid_b32 v84 offset:55360
ds_write_addtid_b32 v85 offset:55616
ds_write_addtid_b32 v86 offset:55872
ds_write_addtid_b32 v87 offset:56128
ds_write_addtid_b32 v88 offset:56384
ds_write_addtid_b32 v89 offset:56640
ds_write_addtid_b32 v90 offset:56896
ds_write_addtid_b32 v91 offset:57152
ds_write_addtid_b32 v92 offset:57408
ds_write_addtid_b32 v93 offset:57664
ds_write_addtid_b32 v94 offset:57920
ds_write_addtid_b32 v95 offset:58176
ds_write_addtid_b32 v96 offset:58432
ds_write_addtid_b32 v97 offset:58688
ds_write_addtid_b32 v98 offset:58944
ds_write_addtid_b32 v99 offset:59200
ds_write_addtid_b32 v100 offset:59456
ds_write_addtid_b32 v101 offset:59712
ds_write_addtid_b32 v102 offset:59968
ds_write_addtid_b32 v103 offset:60224
ds_write_addtid_b32 v104 offset:60480
ds_write_addtid_b32 v105 offset:60736
ds_write_addtid_b32 v106 offset:60992
ds_write_addtid_b32 v107 offset:61248
ds_write_addtid_b32 v108 offset:61504
ds_write_addtid_b32 v109 offset:61760
ds_write_addtid_b32 v110 offset:62016
ds_write_addtid_b32 v111 offset:62272
ds_write_addtid_b32 v112 offset:62528
ds_write_addtid_b32 v113 offset:62784
ds_write_addtid_b32 v114 offset:63040
ds_write_addtid_b32 v115 offset:63296
ds_write_addtid_b32 v116 offset:63552
ds_write_addtid_b32 v117 offset:63808
ds_write_addtid_b32 v118 offset:64064
ds_write_addtid_b32 v119 offset:64320
ds_write_addtid_b32 v120 offset:64576
ds_write_addtid_b32 v121 offset:64832
ds_write_addtid_b32 v122 offset:65088
ds_write_addtid_b32 v123 offset:65344
L_wrd:
s_waitcnt vmcnt(0)
v_mov_b32 v12, v156
v_mov_b32 v13, v157
v_mov_b32 v14, v158
v_mov_b32 v20, v164
v_mov_b32 v21, v165
v_mov_b32 v22, v166
v_mov_b32 v23, v167
v_mov_b32 v24, v168
v_mov_b32 v25, v169
v_mov_b32 v26, v170
v_mov_b32 v27, v171
s_waitcnt lgkmcnt(0)
L_final:
s_waitcnt vmcnt(0)
v_lshlrev_b32 v28, 16, v20
v_and_b32 v29, s35, v20
v_lshlrev_b32 v36, 16, v24
v_and_b32 v37, s35, v24
v_pk_add_f32 v[28:29], v[28:29], v[36:37]
v_lshlrev_b32 v30, 16, v21
v_and_b32 v31, s35, v21
v_lshlrev_b32 v36, 16, v25
v_and_b32 v37, s35, v25
v_pk_add_f32 v[30:31], v[30:31], v[36:37]
v_lshlrev_b32 v32, 16, v22
v_and_b32 v33, s35, v22
v_lshlrev_b32 v36, 16, v24
v_and_b32 v37, s35, v24
v_pk_add_f32 v[32:33], v[32:33], v[36:37]
v_lshlrev_b32 v34, 16, v23
v_and_b32 v35, s35, v23
v_lshlrev_b32 v36, 16, v25
v_and_b32 v37, s35, v25
v_pk_add_f32 v[34:35], v[34:35], v[36:37]
s_barrier
s_mov_b32 s36, s20
s_and_b32 s37, s21, 0xffff
s_mov_b32 s38, 2097152
s_mov_b32 s39, 0x20000
s_and_b32 s52, s26, 3
s_lshl_b32 s52, s52, 12
s_lshr_b32 s53, s26, 2
s_lshl_b32 s53, s53, 11
s_add_u32 s52, s52, s53
v_lshlrev_b32 v40, 8, v14
v_lshl_add_u32 v40, v13, 6, v40
v_and_b32 v41, 3, v0
v_lshl_add_u32 v40, v41, 4, v40
v_add_u32 v40, s52, v40
ds_read_b128 v[128:131], v40 offset:0
ds_read_b128 v[132:135], v40 offset:1024
ds_read_b128 v[136:139], v40 offset:16384
ds_read_b128 v[140:143], v40 offset:17408
ds_read_b128 v[144:147], v40 offset:32768
ds_read_b128 v[148:151], v40 offset:33792
ds_read_b128 v[152:155], v40 offset:49152
ds_read_b128 v[156:159], v40 offset:50176
v_add_u32 v40, 65536, v40
ds_read_b128 v[160:163], v40 offset:0
ds_read_b128 v[164:167], v40 offset:1024
ds_read_b128 v[168:171], v40 offset:16384
ds_read_b128 v[172:175], v40 offset:17408
ds_read_b128 v[176:179], v40 offset:32768
ds_read_b128 v[180:183], v40 offset:33792
ds_read_b128 v[184:187], v40 offset:49152
ds_read_b128 v[188:191], v40 offset:50176
s_waitcnt lgkmcnt(14)
v_pk_add_f32 v[28:29], v[28:29], v[128:129]
v_pk_add_f32 v[30:31], v[30:31], v[130:131]
v_pk_add_f32 v[32:33], v[32:33], v[132:133]
v_pk_add_f32 v[34:35], v[34:35], v[134:135]
s_waitcnt lgkmcnt(12)
v_pk_add_f32 v[28:29], v[28:29], v[136:137]
v_pk_add_f32 v[30:31], v[30:31], v[138:139]
v_pk_add_f32 v[32:33], v[32:33], v[140:141]
v_pk_add_f32 v[34:35], v[34:35], v[142:143]
s_waitcnt lgkmcnt(10)
v_pk_add_f32 v[28:29], v[28:29], v[144:145]
v_pk_add_f32 v[30:31], v[30:31], v[146:147]
v_pk_add_f32 v[32:33], v[32:33], v[148:149]
v_pk_add_f32 v[34:35], v[34:35], v[150:151]
s_waitcnt lgkmcnt(8)
v_pk_add_f32 v[28:29], v[28:29], v[152:153]
v_pk_add_f32 v[30:31], v[30:31], v[154:155]
v_pk_add_f32 v[32:33], v[32:33], v[156:157]
v_pk_add_f32 v[34:35], v[34:35], v[158:159]
s_waitcnt lgkmcnt(6)
v_pk_add_f32 v[28:29], v[28:29], v[160:161]
v_pk_add_f32 v[30:31], v[30:31], v[162:163]
v_pk_add_f32 v[32:33], v[32:33], v[164:165]
v_pk_add_f32 v[34:35], v[34:35], v[166:167]
s_waitcnt lgkmcnt(4)
v_pk_add_f32 v[28:29], v[28:29], v[168:169]
v_pk_add_f32 v[30:31], v[30:31], v[170:171]
v_pk_add_f32 v[32:33], v[32:33], v[172:173]
v_pk_add_f32 v[34:35], v[34:35], v[174:175]
s_waitcnt lgkmcnt(2)
v_pk_add_f32 v[28:29], v[28:29], v[176:177]
v_pk_add_f32 v[30:31], v[30:31], v[178:179]
v_pk_add_f32 v[32:33], v[32:33], v[180:181]
v_pk_add_f32 v[34:35], v[34:35], v[182:183]
s_waitcnt lgkmcnt(0)
v_pk_add_f32 v[28:29], v[28:29], v[184:185]
v_pk_add_f32 v[30:31], v[30:31], v[186:187]
v_pk_add_f32 v[32:33], v[32:33], v[188:189]
v_pk_add_f32 v[34:35], v[34:35], v[190:191]
v_cvt_pk_bf16_f32 v76, v28, v29
v_cvt_pk_bf16_f32 v77, v30, v31
v_cvt_pk_bf16_f32 v78, v32, v33
v_cvt_pk_bf16_f32 v79, v34, v35
buffer_store_dwordx2 v[76:77], v12, s[36:39], 0 offen
s_mov_b32 s52, 16384
buffer_store_dwordx2 v[78:79], v12, s[36:39], s52 offen
L_end:
s_endpgm
L_code_end:
.section .rodata,"a"
.p2align 6
.amdhsa_kernel parallel_sum__sliding_local_dilated__mixer_channel_mlp__prompt_kernel
  .amdhsa_next_free_vgpr 256
  .amdhsa_next_free_sgpr 102
  .amdhsa_accum_offset 256
  .amdhsa_group_segment_fixed_size 0
  .amdhsa_kernarg_size 88
  .amdhsa_user_sgpr_count 2
  .amdhsa_user_sgpr_kernarg_segment_ptr 1
  .amdhsa_system_sgpr_workgroup_id_x 1
.end_amdhsa_kernel
```
